```python
import torch

def _softmax(x, axis=-1):
    return torch.softmax(x, dim=axis)
def _gelu(x):
    return torch.nn.functional.gelu(x, approximate="tanh")
def _silu(x):
    return torch.nn.functional.silu(x)
def _sigmoid(x):
    return torch.sigmoid(x)
def _layernorm(x, axis=-1, eps=1e-5):
    m = x.mean(dim=axis, keepdim=True)
    v = x.var(dim=axis, keepdim=True, unbiased=False)
    return (x - m) / torch.sqrt(v + eps)
def _scatter_add(tgt, idx, src, axis=0):
    return tgt.clone().index_add_(axis, idx, src)
def _segment_sum(src, seg, n):
    out = torch.zeros((n,) + src.shape[1:], dtype=src.dtype)
    return out.index_add_(0, seg, src)
def _pad(x, pw):
    flat = tuple(v for pair in reversed(pw) for v in pair)
    return torch.nn.functional.pad(x, flat)

kernel_name = 'recurrent_scan__gqa_block_cached__glu_gated_reglu__decode'

def setup_inputs():

    _w = (lambda a: (lambda t: t.to(torch.bfloat16) if t.is_floating_point() else t)(torch.as_tensor(a)))
    def _A_setup():
        B, Sq, D = 8, 1, 512
        Hq, Hkv, Sk, Dh = 32, 8, 8192, 128
        assert Hq % Hkv == 0, (Hq, Hkv)
        return {
            "x": _w((lambda *s: torch.randn(*s, dtype=torch.bfloat16) * 0.2)(B, Sq, D)),
            "k_cache": _w((lambda *s: torch.randn(*s, dtype=torch.bfloat16) * 1.6)(B, Hkv, Sk, Dh)),
            "v_cache": _w((lambda *s: torch.randn(*s, dtype=torch.bfloat16) * 1.6)(B, Hkv, Sk, Dh)),
            "wq": _w((lambda *s: torch.randn(*s, dtype=torch.bfloat16) * 1.6)(D, Hq * Dh) * (D ** -0.5)),
            "wo": _w((lambda *s: torch.randn(*s, dtype=torch.bfloat16) * 1.6)(Hq * Dh, D) * ((Hq * Dh) ** -0.5)),
        }
    _A_in = _A_setup()

    def _B_setup():
        B, S, D, F = 8, 1, 512, 1792
        return {
            "x": _w((lambda *s: torch.randn(*s, dtype=torch.bfloat16) * 0.2)(B, S, D)),
            "W_gate": _w((lambda *s: torch.randn(*s, dtype=torch.bfloat16) * 0.8)(D, F) * (2.0 / D) ** 0.5),
            "W_up": _w((lambda *s: torch.randn(*s, dtype=torch.bfloat16) * 0.8)(D, F) * (2.0 / D) ** 0.5),
            "W_down": _w((lambda *s: torch.randn(*s, dtype=torch.bfloat16) * 0.8)(F, D) * (1.0 / F) ** 0.5),
        }
    _B_in = _B_setup()

    return {
        "A_x": _A_in["x"],
        "A_k_cache": _A_in["k_cache"],
        "A_v_cache": _A_in["v_cache"],
        "A_wq": _A_in["wq"],
        "A_wo": _A_in["wo"],
        "B_x": _B_in["x"],
        "B_W_gate": _B_in["W_gate"],
        "B_W_up": _B_in["W_up"],
        "B_W_down": _B_in["W_down"],
    }

def reference(A_x, A_k_cache, A_v_cache, A_wq, A_wo, B_x, B_W_gate, B_W_up, B_W_down):
    def _A_ref(x, k_cache, v_cache, wq, wo):
        B, Sq, D = x.shape
        Hq, Dh = 32, 128
        Hkv = k_cache.shape[1]
        rep = Hq // Hkv
        q = (lambda x, *d: x.permute(*d))((x @ wq).reshape(B, Sq, Hq, Dh), 0, 2, 1, 3)
        k = (lambda x, n, axis: torch.repeat_interleave(x, n, dim=axis))(k_cache, rep, axis=1)
        v = (lambda x, n, axis: torch.repeat_interleave(x, n, dim=axis))(v_cache, rep, axis=1)
        scores = torch.einsum("bhqd,bhkd->bhqk", q, k) * (Dh ** -0.5)
        p = _softmax(scores, axis=-1)
        o = torch.einsum("bhqk,bhkd->bhqd", p, v)
        return (lambda x, *d: x.permute(*d))(o, 0, 2, 1, 3).reshape(B, Sq, Hq * Dh) @ wo

    def _B_ref(x, W_gate, W_up, W_down):
        gate = torch.einsum("bsd,df->bsf", x, W_gate)
        up = torch.einsum("bsd,df->bsf", x, W_up)
        gate = gate * (lambda x, dt: x.to(dt))(gate > 0, gate.dtype)
        h = gate * up
        return torch.einsum("bsf,fd->bsd", h, W_down)

    x = A_x
    xn = _layernorm(x, axis=-1)
    s = _A_ref(xn, A_k_cache, A_v_cache, A_wq, A_wo)
    g = _silu(_B_ref(xn, B_W_gate, B_W_up, B_W_down))
    return x + s * g
```

```asm
; @launch grid=(256,1,1) block=(512,1,1) lds=44352
.amdgcn_target "amdgcn-amd-amdhsa--gfx950"
.text
.globl recurrent_scan__gqa_block_cached__glu_gated_reglu__decode_kernel
.p2align 8
.type recurrent_scan__gqa_block_cached__glu_gated_reglu__decode_kernel,@function
recurrent_scan__gqa_block_cached__glu_gated_reglu__decode_kernel:
    s_cmp_ge_u32 s2, 256
    s_cbranch_scc1 k_end
    s_load_dwordx4 s[4:7], s[0:1], 8
    s_load_dwordx4 s[8:11], s[0:1], 24
    s_load_dwordx4 s[12:15], s[0:1], 48
    s_load_dwordx4 s[48:51], s[0:1], 64
    s_load_dwordx4 s[52:55], s[0:1], 80
    s_load_dwordx2 s[56:57], s[0:1], 0
    v_lshrrev_b32 v1, 6, v0
    v_and_b32 v2, 63, v0
    s_nop 0
    v_readfirstlane_b32 s16, v1
    s_mov_b32 s89, 0
    s_mov_b32 s40, 0x05040100
    s_mov_b32 s41, 0x07060302
    s_mov_b32 s42, 0x3fb8aa3b
    s_mov_b32 s43, 0x3db504f3
    v_lshrrev_b32 v3, 4, v2
    v_and_b32 v4, 15, v2
    v_and_b32 v5, 3, v4
    v_lshlrev_b32 v5, 2, v5
    v_lshrrev_b32 v6, 2, v4
    v_add_u32 v5, v5, v6
    v_lshlrev_b32 v5, 8, v5
    v_lshlrev_b32 v6, 4, v3
    v_add_u32 v5, v5, v6
    v_lshlrev_b32 v6, 8, v3
    v_lshlrev_b32 v7, 4, v4
    v_add_u32 v6, v6, v7
    s_lshr_b32 s17, s2, 2
    s_lshl_b32 s17, s17, 21
    s_and_b32 s18, s2, 3
    s_lshl_b32 s18, s18, 13
    s_lshr_b32 s80, s2, 2
    s_and_b32 s81, s2, 3
    s_waitcnt lgkmcnt(0)
    s_mov_b32 s20, s4
    s_mov_b32 s21, s5
    s_mov_b32 s22, 0x8000000
    s_mov_b32 s23, 0x00020000
    s_mov_b32 s24, s6
    s_mov_b32 s25, s7
    s_mov_b32 s26, 0x8000000
    s_mov_b32 s27, 0x00020000
    s_mov_b32 s44, s54
    s_mov_b32 s45, s55
    s_mov_b32 s46, 0x800000
    s_mov_b32 s47, 0x00020000
    s_mov_b32 s64, s56
    s_mov_b32 s65, s57
    s_mov_b32 s66, 0x2000
    s_mov_b32 s67, 0x00020000
    s_mov_b32 s68, s52
    s_mov_b32 s69, s53
    s_mov_b32 s70, 0x100
    s_mov_b32 s71, 0x00020000
    s_mov_b32 s76, s50
    s_mov_b32 s77, s51
    s_mov_b32 s78, 0x2000
    s_mov_b32 s79, 0x00020000
    s_mov_b32 s60, s8
    s_mov_b32 s61, s9
    s_mov_b32 s62, 0x400000
    s_mov_b32 s63, 0x00020000
    s_mov_b32 s82, 8192
    s_lshl_b32 s83, s80, 8
    s_cmp_lt_u32 s80, 32
    s_cbranch_scc1 h_sel_done
    s_mov_b32 s62, 1835008
    s_mov_b32 s82, 3584
    s_cmp_lt_u32 s80, 46
    s_cbranch_scc0 h_sel_up
    s_mov_b32 s60, s12
    s_mov_b32 s61, s13
    s_sub_u32 s83, s80, 32
    s_lshl_b32 s83, s83, 8
    s_branch h_sel_done
h_sel_up:
    s_mov_b32 s60, s14
    s_mov_b32 s61, s15
    s_sub_u32 s83, s80, 46
    s_lshl_b32 s83, s83, 8
h_sel_done:
    s_mov_b32 s72, s10
    s_mov_b32 s73, s11
    s_mov_b32 s74, 0x400000
    s_mov_b32 s75, 0x00020000
    s_mov_b32 s84, s80
    s_cmp_lt_u32 s80, 32
    s_cbranch_scc1 t_sel_done
    s_mov_b32 s72, s48
    s_mov_b32 s73, s49
    s_mov_b32 s74, 1835008
    s_sub_u32 s84, s80, 32
t_sel_done:
    s_lshl_b32 s36, s16, 10
    v_lshlrev_b32 v8, 4, v2
    v_add_u32 v8, s36, v8
    buffer_load_dwordx4 v[224:227], v8, s[64:67], 0 offen
    s_barrier
    s_cmp_lg_u32 s16, 0
    s_cbranch_scc1 h_hi1
    s_cmp_lg_u32 s2, 0
    s_cbranch_scc1 h_nonon
    s_memrealtime s[86:87]
    s_waitcnt lgkmcnt(0)
    s_or_b32 s86, s86, 1
    v_mov_b32 v12, s86
    v_mov_b32 v13, s87
    v_mov_b32 v11, 0
    s_mov_b64 exec, 1
    buffer_store_dwordx2 v[12:13], v11, s[68:71], 0 offen sc1
    s_mov_b64 exec, -1
h_nonon:
    s_lshl_b32 s19, s81, 7
    v_lshlrev_b32 v9, 3, v3
    v_add_u32 v9, s19, v9
    v_mul_lo_u32 v10, v9, s82
    v_lshlrev_b32 v11, 4, v4
    v_add_u32 v10, v10, v11
    v_add_u32 v10, s83, v10
    s_cmp_lt_u32 s2, 240
    s_cselect_b32 s36, 0, 0x7f000000
    s_mul_i32 s37, s82, 24
    buffer_load_dwordx4 v[16:19], v10, s[60:63], s36 offen
    s_add_u32 s36, s36, s82
    buffer_load_dwordx4 v[20:23], v10, s[60:63], s36 offen
    s_add_u32 s36, s36, s82
    buffer_load_dwordx4 v[24:27], v10, s[60:63], s36 offen
    s_add_u32 s36, s36, s82
    buffer_load_dwordx4 v[28:31], v10, s[60:63], s36 offen
    s_add_u32 s36, s36, s82
    buffer_load_dwordx4 v[32:35], v10, s[60:63], s36 offen
    s_add_u32 s36, s36, s82
    buffer_load_dwordx4 v[36:39], v10, s[60:63], s36 offen
    s_add_u32 s36, s36, s82
    buffer_load_dwordx4 v[40:43], v10, s[60:63], s36 offen
    s_add_u32 s36, s36, s82
    buffer_load_dwordx4 v[44:47], v10, s[60:63], s36 offen
    s_add_u32 s36, s36, s82
    s_add_u32 s36, s36, s37
    buffer_load_dwordx4 v[48:51], v10, s[60:63], s36 offen
    s_add_u32 s36, s36, s82
    buffer_load_dwordx4 v[52:55], v10, s[60:63], s36 offen
    s_add_u32 s36, s36, s82
    buffer_load_dwordx4 v[56:59], v10, s[60:63], s36 offen
    s_add_u32 s36, s36, s82
    buffer_load_dwordx4 v[60:63], v10, s[60:63], s36 offen
    s_add_u32 s36, s36, s82
    buffer_load_dwordx4 v[64:67], v10, s[60:63], s36 offen
    s_add_u32 s36, s36, s82
    buffer_load_dwordx4 v[68:71], v10, s[60:63], s36 offen
    s_add_u32 s36, s36, s82
    buffer_load_dwordx4 v[72:75], v10, s[60:63], s36 offen
    s_add_u32 s36, s36, s82
    buffer_load_dwordx4 v[76:79], v10, s[60:63], s36 offen
    s_add_u32 s36, s36, s82
    s_add_u32 s36, s36, s37
    buffer_load_dwordx4 v[80:83], v10, s[60:63], s36 offen
    s_add_u32 s36, s36, s82
    buffer_load_dwordx4 v[84:87], v10, s[60:63], s36 offen
    s_add_u32 s36, s36, s82
    buffer_load_dwordx4 v[88:91], v10, s[60:63], s36 offen
    s_add_u32 s36, s36, s82
    buffer_load_dwordx4 v[92:95], v10, s[60:63], s36 offen
    s_add_u32 s36, s36, s82
    buffer_load_dwordx4 v[96:99], v10, s[60:63], s36 offen
    s_add_u32 s36, s36, s82
    buffer_load_dwordx4 v[100:103], v10, s[60:63], s36 offen
    s_add_u32 s36, s36, s82
    buffer_load_dwordx4 v[104:107], v10, s[60:63], s36 offen
    s_add_u32 s36, s36, s82
    buffer_load_dwordx4 v[108:111], v10, s[60:63], s36 offen
    s_add_u32 s36, s36, s82
    s_add_u32 s36, s36, s37
    buffer_load_dwordx4 v[112:115], v10, s[60:63], s36 offen
    s_add_u32 s36, s36, s82
    buffer_load_dwordx4 v[116:119], v10, s[60:63], s36 offen
    s_add_u32 s36, s36, s82
    buffer_load_dwordx4 v[120:123], v10, s[60:63], s36 offen
    s_add_u32 s36, s36, s82
    buffer_load_dwordx4 v[124:127], v10, s[60:63], s36 offen
    s_add_u32 s36, s36, s82
    buffer_load_dwordx4 v[128:131], v10, s[60:63], s36 offen
    s_add_u32 s36, s36, s82
    buffer_load_dwordx4 v[132:135], v10, s[60:63], s36 offen
    s_add_u32 s36, s36, s82
    buffer_load_dwordx4 v[136:139], v10, s[60:63], s36 offen
    s_add_u32 s36, s36, s82
    buffer_load_dwordx4 v[140:143], v10, s[60:63], s36 offen
    s_add_u32 s36, s36, s82
    s_add_u32 s36, s36, s37
    v_mov_b32 v11, 6
    v_mov_b32 v12, 44288
    ds_write_b32 v12, v11
    v_mov_b32 v13, 0
    ds_write_b32 v12, v13 offset:16
    s_waitcnt vmcnt(32)
    s_branch h_ln
h_hi1:
    s_waitcnt vmcnt(0)
h_ln:
    v_lshlrev_b32 v228, 16, v224
    v_and_b32 v229, 0xffff0000, v224
    v_lshlrev_b32 v230, 16, v225
    v_and_b32 v231, 0xffff0000, v225
    v_lshlrev_b32 v232, 16, v226
    v_and_b32 v233, 0xffff0000, v226
    v_lshlrev_b32 v234, 16, v227
    v_and_b32 v235, 0xffff0000, v227
    v_add_f32 v236, v228, v229
    v_add_f32 v236, v236, v230
    v_add_f32 v236, v236, v231
    v_add_f32 v236, v236, v232
    v_add_f32 v236, v236, v233
    v_add_f32 v236, v236, v234
    v_add_f32 v236, v236, v235
    s_nop 1
    v_add_f32_dpp v236, v236, v236 quad_perm:[1,0,3,2] row_mask:0xf bank_mask:0xf
    s_nop 1
    v_add_f32_dpp v236, v236, v236 quad_perm:[2,3,0,1] row_mask:0xf bank_mask:0xf
    s_nop 1
    v_add_f32_dpp v236, v236, v236 row_half_mirror row_mask:0xf bank_mask:0xf
    s_nop 1
    v_add_f32_dpp v236, v236, v236 row_mirror row_mask:0xf bank_mask:0xf
    v_mov_b32 v239, v236
    v_mov_b32 v240, v236
    s_nop 1
    v_permlane16_swap_b32 v239, v240
    s_nop 0
    v_add_f32 v236, v239, v240
    v_mov_b32 v239, v236
    v_mov_b32 v240, v236
    s_nop 1
    v_permlane32_swap_b32 v239, v240
    s_nop 0
    v_add_f32 v236, v239, v240
    v_mul_f32 v236, 0x3b000000, v236
    v_sub_f32 v238, v228, v236
    v_mul_f32 v237, v238, v238
    v_sub_f32 v238, v229, v236
    v_fmac_f32 v237, v238, v238
    v_sub_f32 v238, v230, v236
    v_fmac_f32 v237, v238, v238
    v_sub_f32 v238, v231, v236
    v_fmac_f32 v237, v238, v238
    v_sub_f32 v238, v232, v236
    v_fmac_f32 v237, v238, v238
    v_sub_f32 v238, v233, v236
    v_fmac_f32 v237, v238, v238
    v_sub_f32 v238, v234, v236
    v_fmac_f32 v237, v238, v238
    v_sub_f32 v238, v235, v236
    v_fmac_f32 v237, v238, v238
    s_nop 1
    v_add_f32_dpp v237, v237, v237 quad_perm:[1,0,3,2] row_mask:0xf bank_mask:0xf
    s_nop 1
    v_add_f32_dpp v237, v237, v237 quad_perm:[2,3,0,1] row_mask:0xf bank_mask:0xf
    s_nop 1
    v_add_f32_dpp v237, v237, v237 row_half_mirror row_mask:0xf bank_mask:0xf
    s_nop 1
    v_add_f32_dpp v237, v237, v237 row_mirror row_mask:0xf bank_mask:0xf
    v_mov_b32 v239, v237
    v_mov_b32 v240, v237
    s_nop 1
    v_permlane16_swap_b32 v239, v240
    s_nop 0
    v_add_f32 v237, v239, v240
    v_mov_b32 v239, v237
    v_mov_b32 v240, v237
    s_nop 1
    v_permlane32_swap_b32 v239, v240
    s_nop 0
    v_add_f32 v237, v239, v240
    v_mul_f32 v237, 0x3b000000, v237
    v_cvt_pk_bf16_f32 v236, v236, v236
    v_lshlrev_b32 v236, 16, v236
    v_cvt_pk_bf16_f32 v237, v237, v237
    v_lshlrev_b32 v237, 16, v237
    v_add_f32 v237, 0x3727c5ac, v237
    v_cvt_pk_bf16_f32 v237, v237, v237
    v_lshlrev_b32 v237, 16, v237
    v_sqrt_f32 v237, v237
    s_nop 0
    v_cvt_pk_bf16_f32 v237, v237, v237
    v_lshlrev_b32 v237, 16, v237
    v_rcp_f32 v238, v237
    s_nop 0
    v_sub_f32 v228, v228, v236
    v_cvt_pk_bf16_f32 v228, v228, v228
    v_lshlrev_b32 v228, 16, v228
    v_mul_f32 v239, v228, v238
    v_fma_f32 v240, -v239, v237, v228
    v_fma_f32 v228, v240, v238, v239
    v_sub_f32 v229, v229, v236
    v_cvt_pk_bf16_f32 v229, v229, v229
    v_lshlrev_b32 v229, 16, v229
    v_mul_f32 v239, v229, v238
    v_fma_f32 v240, -v239, v237, v229
    v_fma_f32 v229, v240, v238, v239
    v_sub_f32 v230, v230, v236
    v_cvt_pk_bf16_f32 v230, v230, v230
    v_lshlrev_b32 v230, 16, v230
    v_mul_f32 v239, v230, v238
    v_fma_f32 v240, -v239, v237, v230
    v_fma_f32 v230, v240, v238, v239
    v_sub_f32 v231, v231, v236
    v_cvt_pk_bf16_f32 v231, v231, v231
    v_lshlrev_b32 v231, 16, v231
    v_mul_f32 v239, v231, v238
    v_fma_f32 v240, -v239, v237, v231
    v_fma_f32 v231, v240, v238, v239
    v_sub_f32 v232, v232, v236
    v_cvt_pk_bf16_f32 v232, v232, v232
    v_lshlrev_b32 v232, 16, v232
    v_mul_f32 v239, v232, v238
    v_fma_f32 v240, -v239, v237, v232
    v_fma_f32 v232, v240, v238, v239
    v_sub_f32 v233, v233, v236
    v_cvt_pk_bf16_f32 v233, v233, v233
    v_lshlrev_b32 v233, 16, v233
    v_mul_f32 v239, v233, v238
    v_fma_f32 v240, -v239, v237, v233
    v_fma_f32 v233, v240, v238, v239
    v_sub_f32 v234, v234, v236
    v_cvt_pk_bf16_f32 v234, v234, v234
    v_lshlrev_b32 v234, 16, v234
    v_mul_f32 v239, v234, v238
    v_fma_f32 v240, -v239, v237, v234
    v_fma_f32 v234, v240, v238, v239
    v_sub_f32 v235, v235, v236
    v_cvt_pk_bf16_f32 v235, v235, v235
    v_lshlrev_b32 v235, 16, v235
    v_mul_f32 v239, v235, v238
    v_fma_f32 v240, -v239, v237, v235
    v_fma_f32 v235, v240, v238, v239
    v_cvt_pk_bf16_f32 v224, v228, v229
    v_cvt_pk_bf16_f32 v225, v230, v231
    v_cvt_pk_bf16_f32 v226, v232, v233
    v_cvt_pk_bf16_f32 v227, v234, v235
    ds_write_b128 v8, v[224:227] offset:0
    s_waitcnt lgkmcnt(0)
    s_barrier
    s_cmp_lg_u32 s16, 0
    s_cbranch_scc1 h_hi2
    v_mov_b32 v10, 0
    s_mov_b64 exec, 1
    buffer_load_dwordx2 v[246:247], v10, s[68:71], 0 offen sc1
    s_mov_b64 exec, -1
    v_mov_b32 v208, 0
    v_mov_b32 v209, 0
    v_mov_b32 v210, 0
    v_mov_b32 v211, 0
    v_mov_b32 v212, 0
    v_mov_b32 v213, 0
    v_mov_b32 v214, 0
    v_mov_b32 v215, 0
    v_mov_b32 v216, 0
    v_mov_b32 v217, 0
    v_mov_b32 v218, 0
    v_mov_b32 v219, 0
    v_mov_b32 v220, 0
    v_mov_b32 v221, 0
    v_mov_b32 v222, 0
    v_mov_b32 v223, 0
    v_lshlrev_b32 v11, 10, v4
    v_lshlrev_b32 v12, 1, v9
    v_add_u32 v11, v11, v12
    v_cmp_gt_u32 vcc, 8, v4
    s_and_saveexec_b64 s[38:39], vcc
    ds_read_b128 v[208:211], v11 offset:0
    ds_read_b128 v[212:215], v11 offset:64
    ds_read_b128 v[216:219], v11 offset:128
    ds_read_b128 v[220:223], v11 offset:192
    s_mov_b64 exec, s[38:39]
    s_waitcnt lgkmcnt(0)
    s_waitcnt vmcnt(25)
    v_perm_b32 v144, v20, v16, s40
    v_perm_b32 v145, v28, v24, s40
    v_perm_b32 v146, v36, v32, s40
    v_perm_b32 v147, v44, v40, s40
    v_perm_b32 v148, v20, v16, s41
    v_perm_b32 v149, v28, v24, s41
    v_perm_b32 v150, v36, v32, s41
    v_perm_b32 v151, v44, v40, s41
    v_perm_b32 v152, v21, v17, s40
    v_perm_b32 v153, v29, v25, s40
    v_perm_b32 v154, v37, v33, s40
    v_perm_b32 v155, v45, v41, s40
    v_perm_b32 v156, v21, v17, s41
    v_perm_b32 v157, v29, v25, s41
    v_perm_b32 v158, v37, v33, s41
    v_perm_b32 v159, v45, v41, s41
    v_perm_b32 v160, v22, v18, s40
    v_perm_b32 v161, v30, v26, s40
    v_perm_b32 v162, v38, v34, s40
    v_perm_b32 v163, v46, v42, s40
    v_perm_b32 v164, v22, v18, s41
    v_perm_b32 v165, v30, v26, s41
    v_perm_b32 v166, v38, v34, s41
    v_perm_b32 v167, v46, v42, s41
    v_perm_b32 v168, v23, v19, s40
    v_perm_b32 v169, v31, v27, s40
    v_perm_b32 v170, v39, v35, s40
    v_perm_b32 v171, v47, v43, s40
    v_perm_b32 v172, v23, v19, s41
    v_perm_b32 v173, v31, v27, s41
    v_perm_b32 v174, v39, v35, s41
    v_perm_b32 v175, v47, v43, s41
    s_nop 1
    v_mfma_f32_16x16x32_bf16 v[176:179], v[144:147], v[208:211], 0
    v_mfma_f32_16x16x32_bf16 v[180:183], v[148:151], v[208:211], 0
    v_mfma_f32_16x16x32_bf16 v[184:187], v[152:155], v[208:211], 0
    v_mfma_f32_16x16x32_bf16 v[188:191], v[156:159], v[208:211], 0
    v_mfma_f32_16x16x32_bf16 v[192:195], v[160:163], v[208:211], 0
    v_mfma_f32_16x16x32_bf16 v[196:199], v[164:167], v[208:211], 0
    v_mfma_f32_16x16x32_bf16 v[200:203], v[168:171], v[208:211], 0
    v_mfma_f32_16x16x32_bf16 v[204:207], v[172:175], v[208:211], 0
    s_nop 3
    s_waitcnt vmcnt(17)
    v_perm_b32 v144, v52, v48, s40
    v_perm_b32 v145, v60, v56, s40
    v_perm_b32 v146, v68, v64, s40
    v_perm_b32 v147, v76, v72, s40
    v_perm_b32 v148, v52, v48, s41
    v_perm_b32 v149, v60, v56, s41
    v_perm_b32 v150, v68, v64, s41
    v_perm_b32 v151, v76, v72, s41
    v_perm_b32 v152, v53, v49, s40
    v_perm_b32 v153, v61, v57, s40
    v_perm_b32 v154, v69, v65, s40
    v_perm_b32 v155, v77, v73, s40
    v_perm_b32 v156, v53, v49, s41
    v_perm_b32 v157, v61, v57, s41
    v_perm_b32 v158, v69, v65, s41
    v_perm_b32 v159, v77, v73, s41
    v_perm_b32 v160, v54, v50, s40
    v_perm_b32 v161, v62, v58, s40
    v_perm_b32 v162, v70, v66, s40
    v_perm_b32 v163, v78, v74, s40
    v_perm_b32 v164, v54, v50, s41
    v_perm_b32 v165, v62, v58, s41
    v_perm_b32 v166, v70, v66, s41
    v_perm_b32 v167, v78, v74, s41
    v_perm_b32 v168, v55, v51, s40
    v_perm_b32 v169, v63, v59, s40
    v_perm_b32 v170, v71, v67, s40
    v_perm_b32 v171, v79, v75, s40
    v_perm_b32 v172, v55, v51, s41
    v_perm_b32 v173, v63, v59, s41
    v_perm_b32 v174, v71, v67, s41
    v_perm_b32 v175, v79, v75, s41
    s_nop 1
    v_mfma_f32_16x16x32_bf16 v[176:179], v[144:147], v[212:215], v[176:179]
    v_mfma_f32_16x16x32_bf16 v[180:183], v[148:151], v[212:215], v[180:183]
    v_mfma_f32_16x16x32_bf16 v[184:187], v[152:155], v[212:215], v[184:187]
    v_mfma_f32_16x16x32_bf16 v[188:191], v[156:159], v[212:215], v[188:191]
    v_mfma_f32_16x16x32_bf16 v[192:195], v[160:163], v[212:215], v[192:195]
    v_mfma_f32_16x16x32_bf16 v[196:199], v[164:167], v[212:215], v[196:199]
    v_mfma_f32_16x16x32_bf16 v[200:203], v[168:171], v[212:215], v[200:203]
    v_mfma_f32_16x16x32_bf16 v[204:207], v[172:175], v[212:215], v[204:207]
    s_nop 3
    s_waitcnt vmcnt(9)
    v_perm_b32 v144, v84, v80, s40
    v_perm_b32 v145, v92, v88, s40
    v_perm_b32 v146, v100, v96, s40
    v_perm_b32 v147, v108, v104, s40
    v_perm_b32 v148, v84, v80, s41
    v_perm_b32 v149, v92, v88, s41
    v_perm_b32 v150, v100, v96, s41
    v_perm_b32 v151, v108, v104, s41
    v_perm_b32 v152, v85, v81, s40
    v_perm_b32 v153, v93, v89, s40
    v_perm_b32 v154, v101, v97, s40
    v_perm_b32 v155, v109, v105, s40
    v_perm_b32 v156, v85, v81, s41
    v_perm_b32 v157, v93, v89, s41
    v_perm_b32 v158, v101, v97, s41
    v_perm_b32 v159, v109, v105, s41
    v_perm_b32 v160, v86, v82, s40
    v_perm_b32 v161, v94, v90, s40
    v_perm_b32 v162, v102, v98, s40
    v_perm_b32 v163, v110, v106, s40
    v_perm_b32 v164, v86, v82, s41
    v_perm_b32 v165, v94, v90, s41
    v_perm_b32 v166, v102, v98, s41
    v_perm_b32 v167, v110, v106, s41
    v_perm_b32 v168, v87, v83, s40
    v_perm_b32 v169, v95, v91, s40
    v_perm_b32 v170, v103, v99, s40
    v_perm_b32 v171, v111, v107, s40
    v_perm_b32 v172, v87, v83, s41
    v_perm_b32 v173, v95, v91, s41
    v_perm_b32 v174, v103, v99, s41
    v_perm_b32 v175, v111, v107, s41
    s_nop 1
    v_mfma_f32_16x16x32_bf16 v[176:179], v[144:147], v[216:219], v[176:179]
    v_mfma_f32_16x16x32_bf16 v[180:183], v[148:151], v[216:219], v[180:183]
    v_mfma_f32_16x16x32_bf16 v[184:187], v[152:155], v[216:219], v[184:187]
    v_mfma_f32_16x16x32_bf16 v[188:191], v[156:159], v[216:219], v[188:191]
    v_mfma_f32_16x16x32_bf16 v[192:195], v[160:163], v[216:219], v[192:195]
    v_mfma_f32_16x16x32_bf16 v[196:199], v[164:167], v[216:219], v[196:199]
    v_mfma_f32_16x16x32_bf16 v[200:203], v[168:171], v[216:219], v[200:203]
    v_mfma_f32_16x16x32_bf16 v[204:207], v[172:175], v[216:219], v[204:207]
    s_nop 3
    s_waitcnt vmcnt(1)
    v_perm_b32 v144, v116, v112, s40
    v_perm_b32 v145, v124, v120, s40
    v_perm_b32 v146, v132, v128, s40
    v_perm_b32 v147, v140, v136, s40
    v_perm_b32 v148, v116, v112, s41
    v_perm_b32 v149, v124, v120, s41
    v_perm_b32 v150, v132, v128, s41
    v_perm_b32 v151, v140, v136, s41
    v_perm_b32 v152, v117, v113, s40
    v_perm_b32 v153, v125, v121, s40
    v_perm_b32 v154, v133, v129, s40
    v_perm_b32 v155, v141, v137, s40
    v_perm_b32 v156, v117, v113, s41
    v_perm_b32 v157, v125, v121, s41
    v_perm_b32 v158, v133, v129, s41
    v_perm_b32 v159, v141, v137, s41
    v_perm_b32 v160, v118, v114, s40
    v_perm_b32 v161, v126, v122, s40
    v_perm_b32 v162, v134, v130, s40
    v_perm_b32 v163, v142, v138, s40
    v_perm_b32 v164, v118, v114, s41
    v_perm_b32 v165, v126, v122, s41
    v_perm_b32 v166, v134, v130, s41
    v_perm_b32 v167, v142, v138, s41
    v_perm_b32 v168, v119, v115, s40
    v_perm_b32 v169, v127, v123, s40
    v_perm_b32 v170, v135, v131, s40
    v_perm_b32 v171, v143, v139, s40
    v_perm_b32 v172, v119, v115, s41
    v_perm_b32 v173, v127, v123, s41
    v_perm_b32 v174, v135, v131, s41
    v_perm_b32 v175, v143, v139, s41
    s_nop 1
    v_mfma_f32_16x16x32_bf16 v[176:179], v[144:147], v[220:223], v[176:179]
    v_mfma_f32_16x16x32_bf16 v[180:183], v[148:151], v[220:223], v[180:183]
    v_mfma_f32_16x16x32_bf16 v[184:187], v[152:155], v[220:223], v[184:187]
    v_mfma_f32_16x16x32_bf16 v[188:191], v[156:159], v[220:223], v[188:191]
    v_mfma_f32_16x16x32_bf16 v[192:195], v[160:163], v[220:223], v[192:195]
    v_mfma_f32_16x16x32_bf16 v[196:199], v[164:167], v[220:223], v[196:199]
    v_mfma_f32_16x16x32_bf16 v[200:203], v[168:171], v[220:223], v[200:203]
    v_mfma_f32_16x16x32_bf16 v[204:207], v[172:175], v[220:223], v[204:207]
    s_nop 3
    s_nop 9
    v_mul_u32_u24 v10, 528, v4
    v_lshlrev_b32 v11, 7, v3
    v_add_u32 v10, v10, v11
    v_cmp_gt_u32 vcc, 8, v4
    s_and_saveexec_b64 s[38:39], vcc
    ds_write_b32 v10, v176 offset:8192
    ds_write_b32 v10, v177 offset:8224
    ds_write_b32 v10, v178 offset:8256
    ds_write_b32 v10, v179 offset:8288
    ds_write_b32 v10, v180 offset:8196
    ds_write_b32 v10, v181 offset:8228
    ds_write_b32 v10, v182 offset:8260
    ds_write_b32 v10, v183 offset:8292
    ds_write_b32 v10, v184 offset:8200
    ds_write_b32 v10, v185 offset:8232
    ds_write_b32 v10, v186 offset:8264
    ds_write_b32 v10, v187 offset:8296
    ds_write_b32 v10, v188 offset:8204
    ds_write_b32 v10, v189 offset:8236
    ds_write_b32 v10, v190 offset:8268
    ds_write_b32 v10, v191 offset:8300
    ds_write_b32 v10, v192 offset:8208
    ds_write_b32 v10, v193 offset:8240
    ds_write_b32 v10, v194 offset:8272
    ds_write_b32 v10, v195 offset:8304
    ds_write_b32 v10, v196 offset:8212
    ds_write_b32 v10, v197 offset:8244
    ds_write_b32 v10, v198 offset:8276
    ds_write_b32 v10, v199 offset:8308
    ds_write_b32 v10, v200 offset:8216
    ds_write_b32 v10, v201 offset:8248
    ds_write_b32 v10, v202 offset:8280
    ds_write_b32 v10, v203 offset:8312
    ds_write_b32 v10, v204 offset:8220
    ds_write_b32 v10, v205 offset:8252
    ds_write_b32 v10, v206 offset:8284
    ds_write_b32 v10, v207 offset:8316
    s_mov_b64 exec, s[38:39]
    v_mov_b32 v10, 0
h_npoll:
    s_waitcnt vmcnt(0)
    v_readfirstlane_b32 s86, v246
    v_readfirstlane_b32 s87, v247
    s_cmp_lg_u32 s86, 0
    s_cbranch_scc1 h_gotn
    s_add_u32 s89, s89, 1
    s_cmp_gt_u32 s89, 0x1000000
    s_cbranch_scc1 h_gotn
    s_mov_b64 exec, 1
    buffer_load_dwordx2 v[246:247], v10, s[68:71], 0 offen sc1
    s_mov_b64 exec, -1
    s_branch h_npoll
h_gotn:
    s_waitcnt lgkmcnt(0)
    v_lshlrev_b32 v10, 3, v2
    ds_read_b64 v[16:17], v10 offset:8192
    ds_read_b64 v[20:21], v10 offset:8720
    ds_read_b64 v[24:25], v10 offset:9248
    ds_read_b64 v[28:29], v10 offset:9776
    ds_read_b64 v[32:33], v10 offset:10304
    ds_read_b64 v[36:37], v10 offset:10832
    ds_read_b64 v[40:41], v10 offset:11360
    ds_read_b64 v[44:45], v10 offset:11888
    v_mov_b32 v18, s86
    v_mov_b32 v19, s87
    v_mov_b32 v22, s86
    v_mov_b32 v23, s87
    v_mov_b32 v26, s86
    v_mov_b32 v27, s87
    v_mov_b32 v30, s86
    v_mov_b32 v31, s87
    v_mov_b32 v34, s86
    v_mov_b32 v35, s87
    v_mov_b32 v38, s86
    v_mov_b32 v39, s87
    v_mov_b32 v42, s86
    v_mov_b32 v43, s87
    v_mov_b32 v46, s86
    v_mov_b32 v47, s87
    s_mul_i32 s36, s81, 491520
    s_lshl_b32 s37, s80, 10
    s_add_u32 s36, s36, s37
    s_add_u32 s36, s36, 0
    s_cmp_lt_u32 s2, 240
    s_cselect_b32 s36, s36, 0x7f000000
    v_lshlrev_b32 v11, 4, v2
    s_waitcnt lgkmcnt(0)
    buffer_store_dwordx4 v[16:19], v11, s[44:47], s36 offen sc1
    s_add_u32 s36, s36, 61440
    buffer_store_dwordx4 v[20:23], v11, s[44:47], s36 offen sc1
    s_add_u32 s36, s36, 61440
    buffer_store_dwordx4 v[24:27], v11, s[44:47], s36 offen sc1
    s_add_u32 s36, s36, 61440
    buffer_store_dwordx4 v[28:31], v11, s[44:47], s36 offen sc1
    s_add_u32 s36, s36, 61440
    buffer_store_dwordx4 v[32:35], v11, s[44:47], s36 offen sc1
    s_add_u32 s36, s36, 61440
    buffer_store_dwordx4 v[36:39], v11, s[44:47], s36 offen sc1
    s_add_u32 s36, s36, 61440
    buffer_store_dwordx4 v[40:43], v11, s[44:47], s36 offen sc1
    s_add_u32 s36, s36, 61440
    buffer_store_dwordx4 v[44:47], v11, s[44:47], s36 offen sc1
    s_waitcnt vmcnt(0)
    s_barrier
    v_mov_b32 v12, s86
    v_mov_b32 v13, s87
    v_mov_b32 v10, 44296
    ds_write_b64 v10, v[12:13]
    s_lshr_b32 s32, s2, 5
    s_and_b32 s33, s80, 7
    s_mul_i32 s34, s32, 3840
    s_lshl_b32 s35, s33, 8
    s_add_u32 s34, s34, s35
    v_lshlrev_b32 v10, 2, v2
    v_add_u32 v10, s34, v10
    v_lshlrev_b32 v10, 4, v10
h_poll:
    s_mov_b32 s36, 0
    buffer_load_dwordx4 v[80:83], v10, s[44:47], s36 offen offset:0 sc1
    buffer_load_dwordx4 v[84:87], v10, s[44:47], s36 offen offset:16 sc1
    buffer_load_dwordx4 v[88:91], v10, s[44:47], s36 offen offset:32 sc1
    buffer_load_dwordx4 v[92:95], v10, s[44:47], s36 offen offset:48 sc1
    s_mov_b32 s36, 491520
    buffer_load_dwordx4 v[96:99], v10, s[44:47], s36 offen offset:0 sc1
    buffer_load_dwordx4 v[100:103], v10, s[44:47], s36 offen offset:16 sc1
    buffer_load_dwordx4 v[104:107], v10, s[44:47], s36 offen offset:32 sc1
    buffer_load_dwordx4 v[108:111], v10, s[44:47], s36 offen offset:48 sc1
    s_mov_b32 s36, 983040
    buffer_load_dwordx4 v[112:115], v10, s[44:47], s36 offen offset:0 sc1
    buffer_load_dwordx4 v[116:119], v10, s[44:47], s36 offen offset:16 sc1
    buffer_load_dwordx4 v[120:123], v10, s[44:47], s36 offen offset:32 sc1
    buffer_load_dwordx4 v[124:127], v10, s[44:47], s36 offen offset:48 sc1
    s_mov_b32 s36, 1474560
    buffer_load_dwordx4 v[128:131], v10, s[44:47], s36 offen offset:0 sc1
    buffer_load_dwordx4 v[132:135], v10, s[44:47], s36 offen offset:16 sc1
    buffer_load_dwordx4 v[136:139], v10, s[44:47], s36 offen offset:32 sc1
    buffer_load_dwordx4 v[140:143], v10, s[44:47], s36 offen offset:48 sc1
    s_waitcnt vmcnt(0)
    v_xor_b32 v11, s86, v82
    v_xor_b32 v12, s87, v83
    v_or_b32 v11, v11, v12
    v_xor_b32 v12, s86, v86
    v_or_b32 v11, v11, v12
    v_xor_b32 v12, s87, v87
    v_or_b32 v11, v11, v12
    v_xor_b32 v12, s86, v90
    v_or_b32 v11, v11, v12
    v_xor_b32 v12, s87, v91
    v_or_b32 v11, v11, v12
    v_xor_b32 v12, s86, v94
    v_or_b32 v11, v11, v12
    v_xor_b32 v12, s87, v95
    v_or_b32 v11, v11, v12
    v_xor_b32 v12, s86, v98
    v_or_b32 v11, v11, v12
    v_xor_b32 v12, s87, v99
    v_or_b32 v11, v11, v12
    v_xor_b32 v12, s86, v102
    v_or_b32 v11, v11, v12
    v_xor_b32 v12, s87, v103
    v_or_b32 v11, v11, v12
    v_xor_b32 v12, s86, v106
    v_or_b32 v11, v11, v12
    v_xor_b32 v12, s87, v107
    v_or_b32 v11, v11, v12
    v_xor_b32 v12, s86, v110
    v_or_b32 v11, v11, v12
    v_xor_b32 v12, s87, v111
    v_or_b32 v11, v11, v12
    v_xor_b32 v12, s86, v114
    v_or_b32 v11, v11, v12
    v_xor_b32 v12, s87, v115
    v_or_b32 v11, v11, v12
    v_xor_b32 v12, s86, v118
    v_or_b32 v11, v11, v12
    v_xor_b32 v12, s87, v119
    v_or_b32 v11, v11, v12
    v_xor_b32 v12, s86, v122
    v_or_b32 v11, v11, v12
    v_xor_b32 v12, s87, v123
    v_or_b32 v11, v11, v12
    v_xor_b32 v12, s86, v126
    v_or_b32 v11, v11, v12
    v_xor_b32 v12, s87, v127
    v_or_b32 v11, v11, v12
    v_xor_b32 v12, s86, v130
    v_or_b32 v11, v11, v12
    v_xor_b32 v12, s87, v131
    v_or_b32 v11, v11, v12
    v_xor_b32 v12, s86, v134
    v_or_b32 v11, v11, v12
    v_xor_b32 v12, s87, v135
    v_or_b32 v11, v11, v12
    v_xor_b32 v12, s86, v138
    v_or_b32 v11, v11, v12
    v_xor_b32 v12, s87, v139
    v_or_b32 v11, v11, v12
    v_xor_b32 v12, s86, v142
    v_or_b32 v11, v11, v12
    v_xor_b32 v12, s87, v143
    v_or_b32 v11, v11, v12
    v_cmp_ne_u32 vcc, 0, v11
    s_nop 0
    s_cmp_eq_u64 vcc, 0
    s_cbranch_scc1 h_polled
    s_add_u32 s89, s89, 1
    s_cmp_gt_u32 s89, 0x1000000
    s_cbranch_scc1 h_polled
    s_sleep 2
    s_branch h_poll
h_polled:
    v_add_f32 v80, v80, v96
    v_add_f32 v112, v112, v128
    v_add_f32 v80, v80, v112
    v_add_f32 v81, v81, v97
    v_add_f32 v113, v113, v129
    v_add_f32 v81, v81, v113
    v_cvt_pk_bf16_f32 v232, v80, v81
    v_add_f32 v84, v84, v100
    v_add_f32 v116, v116, v132
    v_add_f32 v84, v84, v116
    v_add_f32 v85, v85, v101
    v_add_f32 v117, v117, v133
    v_add_f32 v85, v85, v117
    v_cvt_pk_bf16_f32 v233, v84, v85
    v_add_f32 v88, v88, v104
    v_add_f32 v120, v120, v136
    v_add_f32 v88, v88, v120
    v_add_f32 v89, v89, v105
    v_add_f32 v121, v121, v137
    v_add_f32 v89, v89, v121
    v_cvt_pk_bf16_f32 v234, v88, v89
    v_add_f32 v92, v92, v108
    v_add_f32 v124, v124, v140
    v_add_f32 v92, v92, v124
    v_add_f32 v93, v93, v109
    v_add_f32 v125, v125, v141
    v_add_f32 v93, v93, v125
    v_cvt_pk_bf16_f32 v235, v92, v93
    v_lshlrev_b32 v10, 4, v2
    ds_write_b128 v10, v[232:235] offset:41216
    s_waitcnt lgkmcnt(0)
    v_mov_b32 v11, 1
    v_mov_b32 v12, 44304
    ds_write_b32 v12, v11
    v_mov_b32 v11, 2
    v_mov_b32 v12, 44288
    s_mov_b64 exec, 1
    ds_add_rtn_u32 v13, v12, v11
    s_mov_b64 exec, -1
    s_waitcnt lgkmcnt(0)
    v_readfirstlane_b32 s28, v13
    s_add_u32 s29, s28, 1
    s_cmp_ge_u32 s28, 64
    s_cbranch_scc1 h_join
    s_mov_b32 s30, s28
    s_lshr_b32 s31, s30, 2
    s_add_u32 s31, s31, s30
    s_add_u32 s31, s31, s81
    s_and_b32 s31, s31, 3
    s_lshl_b32 s31, s31, 13
    s_lshl_b32 s30, s30, 15
    s_add_u32 s30, s30, s31
    s_add_u32 s30, s30, s17
    s_add_u32 s31, s30, 4096
    buffer_load_dwordx4 v[16:19], v5, s[20:23], s30 offen offset:0 nt
    buffer_load_dwordx4 v[20:23], v5, s[20:23], s30 offen offset:64 nt
    buffer_load_dwordx4 v[24:27], v5, s[20:23], s30 offen offset:128 nt
    buffer_load_dwordx4 v[28:31], v5, s[20:23], s30 offen offset:192 nt
    buffer_load_dwordx4 v[32:35], v5, s[20:23], s31 offen offset:0 nt
    buffer_load_dwordx4 v[36:39], v5, s[20:23], s31 offen offset:64 nt
    buffer_load_dwordx4 v[40:43], v5, s[20:23], s31 offen offset:128 nt
    buffer_load_dwordx4 v[44:47], v5, s[20:23], s31 offen offset:192 nt
    s_mov_b32 s30, s28
    s_lshr_b32 s31, s30, 2
    s_add_u32 s31, s31, s30
    s_add_u32 s31, s31, s81
    s_and_b32 s31, s31, 3
    s_lshl_b32 s31, s31, 13
    s_lshl_b32 s30, s30, 15
    s_add_u32 s30, s30, s31
    s_add_u32 s30, s30, s17
    s_add_u32 s31, s30, 4096
    buffer_load_dwordx4 v[80:83], v6, s[24:27], s30 offen offset:0 nt
    buffer_load_dwordx4 v[84:87], v6, s[24:27], s30 offen offset:1024 nt
    buffer_load_dwordx4 v[88:91], v6, s[24:27], s30 offen offset:2048 nt
    buffer_load_dwordx4 v[92:95], v6, s[24:27], s30 offen offset:3072 nt
    buffer_load_dwordx4 v[96:99], v6, s[24:27], s31 offen offset:0 nt
    buffer_load_dwordx4 v[100:103], v6, s[24:27], s31 offen offset:1024 nt
    buffer_load_dwordx4 v[104:107], v6, s[24:27], s31 offen offset:2048 nt
    buffer_load_dwordx4 v[108:111], v6, s[24:27], s31 offen offset:3072 nt
    s_cmp_ge_u32 s29, 64
    s_cbranch_scc1 h_join
    s_mov_b32 s30, s29
    s_lshr_b32 s31, s30, 2
    s_add_u32 s31, s31, s30
    s_add_u32 s31, s31, s81
    s_and_b32 s31, s31, 3
    s_lshl_b32 s31, s31, 13
    s_lshl_b32 s30, s30, 15
    s_add_u32 s30, s30, s31
    s_add_u32 s30, s30, s17
    s_add_u32 s31, s30, 4096
    buffer_load_dwordx4 v[48:51], v5, s[20:23], s30 offen offset:0 nt
    buffer_load_dwordx4 v[52:55], v5, s[20:23], s30 offen offset:64 nt
    buffer_load_dwordx4 v[56:59], v5, s[20:23], s30 offen offset:128 nt
    buffer_load_dwordx4 v[60:63], v5, s[20:23], s30 offen offset:192 nt
    buffer_load_dwordx4 v[64:67], v5, s[20:23], s31 offen offset:0 nt
    buffer_load_dwordx4 v[68:71], v5, s[20:23], s31 offen offset:64 nt
    buffer_load_dwordx4 v[72:75], v5, s[20:23], s31 offen offset:128 nt
    buffer_load_dwordx4 v[76:79], v5, s[20:23], s31 offen offset:192 nt
    s_mov_b32 s30, s29
    s_lshr_b32 s31, s30, 2
    s_add_u32 s31, s31, s30
    s_add_u32 s31, s31, s81
    s_and_b32 s31, s31, 3
    s_lshl_b32 s31, s31, 13
    s_lshl_b32 s30, s30, 15
    s_add_u32 s30, s30, s31
    s_add_u32 s30, s30, s17
    s_add_u32 s31, s30, 4096
    buffer_load_dwordx4 v[112:115], v6, s[24:27], s30 offen offset:0 nt
    buffer_load_dwordx4 v[116:119], v6, s[24:27], s30 offen offset:1024 nt
    buffer_load_dwordx4 v[120:123], v6, s[24:27], s30 offen offset:2048 nt
    buffer_load_dwordx4 v[124:127], v6, s[24:27], s30 offen offset:3072 nt
    buffer_load_dwordx4 v[128:131], v6, s[24:27], s31 offen offset:0 nt
    buffer_load_dwordx4 v[132:135], v6, s[24:27], s31 offen offset:1024 nt
    buffer_load_dwordx4 v[136:139], v6, s[24:27], s31 offen offset:2048 nt
    buffer_load_dwordx4 v[140:143], v6, s[24:27], s31 offen offset:3072 nt
    s_branch h_join
h_hi2:
    s_barrier
    s_sub_u32 s28, s16, 1
    s_lshl_b32 s28, s28, 1
    s_add_u32 s29, s28, 1
    v_mov_b32 v12, 44304
    s_cmp_lt_u32 s16, 4
    s_cbranch_scc1 h_strm
    s_mov_b32 s28, 64
    s_mov_b32 s29, 64
    s_branch h_spin
h_strm:
    s_mov_b32 s30, s28
    s_lshr_b32 s31, s30, 2
    s_add_u32 s31, s31, s30
    s_add_u32 s31, s31, s81
    s_and_b32 s31, s31, 3
    s_lshl_b32 s31, s31, 13
    s_lshl_b32 s30, s30, 15
    s_add_u32 s30, s30, s31
    s_add_u32 s30, s30, s17
    s_add_u32 s31, s30, 4096
    buffer_load_dwordx4 v[16:19], v5, s[20:23], s30 offen offset:0 nt
    buffer_load_dwordx4 v[20:23], v5, s[20:23], s30 offen offset:64 nt
    buffer_load_dwordx4 v[24:27], v5, s[20:23], s30 offen offset:128 nt
    buffer_load_dwordx4 v[28:31], v5, s[20:23], s30 offen offset:192 nt
    buffer_load_dwordx4 v[32:35], v5, s[20:23], s31 offen offset:0 nt
    buffer_load_dwordx4 v[36:39], v5, s[20:23], s31 offen offset:64 nt
    buffer_load_dwordx4 v[40:43], v5, s[20:23], s31 offen offset:128 nt
    buffer_load_dwordx4 v[44:47], v5, s[20:23], s31 offen offset:192 nt
    buffer_load_dwordx4 v[80:83], v6, s[24:27], s30 offen offset:0 nt
    buffer_load_dwordx4 v[84:87], v6, s[24:27], s30 offen offset:1024 nt
    buffer_load_dwordx4 v[88:91], v6, s[24:27], s30 offen offset:2048 nt
    buffer_load_dwordx4 v[92:95], v6, s[24:27], s30 offen offset:3072 nt
    buffer_load_dwordx4 v[96:99], v6, s[24:27], s31 offen offset:0 nt
    buffer_load_dwordx4 v[100:103], v6, s[24:27], s31 offen offset:1024 nt
    buffer_load_dwordx4 v[104:107], v6, s[24:27], s31 offen offset:2048 nt
    buffer_load_dwordx4 v[108:111], v6, s[24:27], s31 offen offset:3072 nt
    s_mov_b32 s30, s29
    s_lshr_b32 s31, s30, 2
    s_add_u32 s31, s31, s30
    s_add_u32 s31, s31, s81
    s_and_b32 s31, s31, 3
    s_lshl_b32 s31, s31, 13
    s_lshl_b32 s30, s30, 15
    s_add_u32 s30, s30, s31
    s_add_u32 s30, s30, s17
    s_add_u32 s31, s30, 4096
    buffer_load_dwordx4 v[48:51], v5, s[20:23], s30 offen offset:0 nt
    buffer_load_dwordx4 v[52:55], v5, s[20:23], s30 offen offset:64 nt
    buffer_load_dwordx4 v[56:59], v5, s[20:23], s30 offen offset:128 nt
    buffer_load_dwordx4 v[60:63], v5, s[20:23], s30 offen offset:192 nt
    buffer_load_dwordx4 v[64:67], v5, s[20:23], s31 offen offset:0 nt
    buffer_load_dwordx4 v[68:71], v5, s[20:23], s31 offen offset:64 nt
    buffer_load_dwordx4 v[72:75], v5, s[20:23], s31 offen offset:128 nt
    buffer_load_dwordx4 v[76:79], v5, s[20:23], s31 offen offset:192 nt
    buffer_load_dwordx4 v[112:115], v6, s[24:27], s30 offen offset:0 nt
    buffer_load_dwordx4 v[116:119], v6, s[24:27], s30 offen offset:1024 nt
    buffer_load_dwordx4 v[120:123], v6, s[24:27], s30 offen offset:2048 nt
    buffer_load_dwordx4 v[124:127], v6, s[24:27], s30 offen offset:3072 nt
    buffer_load_dwordx4 v[128:131], v6, s[24:27], s31 offen offset:0 nt
    buffer_load_dwordx4 v[132:135], v6, s[24:27], s31 offen offset:1024 nt
    buffer_load_dwordx4 v[136:139], v6, s[24:27], s31 offen offset:2048 nt
    buffer_load_dwordx4 v[140:143], v6, s[24:27], s31 offen offset:3072 nt
h_spin:
    ds_read_b32 v11, v12
    s_waitcnt lgkmcnt(0)
    v_readfirstlane_b32 s36, v11
    s_cmp_lg_u32 s36, 0
    s_cbranch_scc1 h_join
    s_sleep 2
    s_branch h_spin
h_join:
    v_mov_b32 v10, 44296
    ds_read_b64 v[12:13], v10
    v_mov_b32 v208, 0
    v_mov_b32 v209, 0
    v_mov_b32 v210, 0
    v_mov_b32 v211, 0
    v_mov_b32 v212, 0
    v_mov_b32 v213, 0
    v_mov_b32 v214, 0
    v_mov_b32 v215, 0
    v_mov_b32 v216, 0
    v_mov_b32 v217, 0
    v_mov_b32 v218, 0
    v_mov_b32 v219, 0
    v_mov_b32 v220, 0
    v_mov_b32 v221, 0
    v_mov_b32 v222, 0
    v_mov_b32 v223, 0
    v_lshlrev_b32 v8, 8, v4
    v_lshlrev_b32 v9, 4, v3
    v_add_u32 v8, v8, v9
    v_cmp_gt_u32 vcc, 4, v4
    s_and_saveexec_b64 s[38:39], vcc
    ds_read_b128 v[208:211], v8 offset:41216
    ds_read_b128 v[212:215], v8 offset:41280
    ds_read_b128 v[216:219], v8 offset:41344
    ds_read_b128 v[220:223], v8 offset:41408
    s_mov_b64 exec, s[38:39]
    v_mov_b32 v176, 0
    v_mov_b32 v177, 0
    v_mov_b32 v178, 0
    v_mov_b32 v179, 0
    v_mov_b32 v180, 0
    v_mov_b32 v181, 0
    v_mov_b32 v182, 0
    v_mov_b32 v183, 0
    v_mov_b32 v184, 0
    v_mov_b32 v185, 0
    v_mov_b32 v186, 0
    v_mov_b32 v187, 0
    v_mov_b32 v188, 0
    v_mov_b32 v189, 0
    v_mov_b32 v190, 0
    v_mov_b32 v191, 0
    v_mov_b32 v192, 0
    v_mov_b32 v193, 0
    v_mov_b32 v194, 0
    v_mov_b32 v195, 0
    v_mov_b32 v196, 0
    v_mov_b32 v197, 0
    v_mov_b32 v198, 0
    v_mov_b32 v199, 0
    v_mov_b32 v200, 0
    v_mov_b32 v201, 0
    v_mov_b32 v202, 0
    v_mov_b32 v203, 0
    v_mov_b32 v204, 0
    v_mov_b32 v205, 0
    v_mov_b32 v206, 0
    v_mov_b32 v207, 0
    v_mov_b32 v248, 0xff800000
    v_mov_b32 v249, 0
    v_mov_b32 v14, 1
    v_mov_b32 v15, 44288
    s_waitcnt lgkmcnt(0)
    v_readfirstlane_b32 s86, v12
    v_readfirstlane_b32 s87, v13
    s_nop 1
m_loop:
    s_cmp_ge_u32 s28, 64
    s_cbranch_scc1 m_done
    s_mov_b64 exec, 1
    ds_add_rtn_u32 v13, v15, v14
    s_mov_b64 exec, -1
    s_cmp_ge_u32 s29, 64
    s_cbranch_scc1 m0_w1b
    s_waitcnt vmcnt(24)
    s_branch m0_w1c
m0_w1b:
    s_waitcnt vmcnt(8)
m0_w1c:
    v_mfma_f32_16x16x32_bf16 v[224:227], v[16:19], v[208:211], 0
    v_mfma_f32_16x16x32_bf16 v[224:227], v[20:23], v[212:215], v[224:227]
    v_mfma_f32_16x16x32_bf16 v[224:227], v[24:27], v[216:219], v[224:227]
    v_mfma_f32_16x16x32_bf16 v[224:227], v[28:31], v[220:223], v[224:227]
    v_mfma_f32_16x16x32_bf16 v[228:231], v[32:35], v[208:211], 0
    v_mfma_f32_16x16x32_bf16 v[228:231], v[36:39], v[212:215], v[228:231]
    v_mfma_f32_16x16x32_bf16 v[228:231], v[40:43], v[216:219], v[228:231]
    v_mfma_f32_16x16x32_bf16 v[228:231], v[44:47], v[220:223], v[228:231]
    s_waitcnt lgkmcnt(0)
    v_readfirstlane_b32 s28, v13
    s_cmp_ge_u32 s28, 64
    s_cbranch_scc1 m0_nok
    s_mov_b32 s30, s28
    s_lshr_b32 s31, s30, 2
    s_add_u32 s31, s31, s30
    s_add_u32 s31, s31, s81
    s_and_b32 s31, s31, 3
    s_lshl_b32 s31, s31, 13
    s_lshl_b32 s30, s30, 15
    s_add_u32 s30, s30, s31
    s_add_u32 s30, s30, s17
    s_add_u32 s31, s30, 4096
    buffer_load_dwordx4 v[16:19], v5, s[20:23], s30 offen offset:0 nt
    buffer_load_dwordx4 v[20:23], v5, s[20:23], s30 offen offset:64 nt
    buffer_load_dwordx4 v[24:27], v5, s[20:23], s30 offen offset:128 nt
    buffer_load_dwordx4 v[28:31], v5, s[20:23], s30 offen offset:192 nt
    buffer_load_dwordx4 v[32:35], v5, s[20:23], s31 offen offset:0 nt
    buffer_load_dwordx4 v[36:39], v5, s[20:23], s31 offen offset:64 nt
    buffer_load_dwordx4 v[40:43], v5, s[20:23], s31 offen offset:128 nt
    buffer_load_dwordx4 v[44:47], v5, s[20:23], s31 offen offset:192 nt
m0_nok:
    s_nop 7
    v_cvt_pk_bf16_f32 v240, v224, v225
    v_cvt_pk_bf16_f32 v241, v226, v227
    v_cvt_pk_bf16_f32 v242, v228, v229
    v_cvt_pk_bf16_f32 v243, v230, v231
    v_lshlrev_b32 v232, 16, v240
    v_and_b32 v233, 0xffff0000, v240
    v_lshlrev_b32 v234, 16, v241
    v_and_b32 v235, 0xffff0000, v241
    v_lshlrev_b32 v236, 16, v242
    v_and_b32 v237, 0xffff0000, v242
    v_lshlrev_b32 v238, 16, v243
    v_and_b32 v239, 0xffff0000, v243
    v_mul_f32 v232, s43, v232
    v_mul_f32 v233, s43, v233
    v_mul_f32 v234, s43, v234
    v_mul_f32 v235, s43, v235
    v_mul_f32 v236, s43, v236
    v_mul_f32 v237, s43, v237
    v_mul_f32 v238, s43, v238
    v_mul_f32 v239, s43, v239
    v_cvt_pk_bf16_f32 v240, v232, v233
    v_cvt_pk_bf16_f32 v241, v234, v235
    v_cvt_pk_bf16_f32 v242, v236, v237
    v_cvt_pk_bf16_f32 v243, v238, v239
    v_lshlrev_b32 v232, 16, v240
    v_and_b32 v233, 0xffff0000, v240
    v_lshlrev_b32 v234, 16, v241
    v_and_b32 v235, 0xffff0000, v241
    v_lshlrev_b32 v236, 16, v242
    v_and_b32 v237, 0xffff0000, v242
    v_lshlrev_b32 v238, 16, v243
    v_and_b32 v239, 0xffff0000, v243
    v_max3_f32 v250, v232, v233, v234
    v_max3_f32 v250, v250, v235, v236
    v_max3_f32 v250, v250, v237, v238
    v_max_f32 v250, v250, v239
    v_mov_b32 v252, v250
    v_mov_b32 v253, v250
    s_nop 1
    v_permlane16_swap_b32 v252, v253
    s_nop 0
    v_max_f32 v250, v252, v253
    v_mov_b32 v252, v250
    v_mov_b32 v253, v250
    s_nop 1
    v_permlane32_swap_b32 v252, v253
    s_nop 0
    v_max_f32 v250, v252, v253
    v_max_f32 v252, v248, v250
    v_sub_f32 v253, v248, v252
    v_mul_f32 v253, s42, v253
    v_exp_f32 v250, v253
    v_mov_b32 v248, v252
    v_mul_f32 v251, s42, v248
    v_fma_f32 v232, v232, s42, -v251
    v_fma_f32 v233, v233, s42, -v251
    v_fma_f32 v234, v234, s42, -v251
    v_fma_f32 v235, v235, s42, -v251
    v_fma_f32 v236, v236, s42, -v251
    v_fma_f32 v237, v237, s42, -v251
    v_fma_f32 v238, v238, s42, -v251
    v_fma_f32 v239, v239, s42, -v251
    v_exp_f32 v232, v232
    v_exp_f32 v233, v233
    v_exp_f32 v234, v234
    v_exp_f32 v235, v235
    v_exp_f32 v236, v236
    v_exp_f32 v237, v237
    v_exp_f32 v238, v238
    v_exp_f32 v239, v239
    s_nop 0
    v_cvt_pk_bf16_f32 v244, v232, v233
    v_cvt_pk_bf16_f32 v245, v234, v235
    v_cvt_pk_bf16_f32 v246, v236, v237
    v_cvt_pk_bf16_f32 v247, v238, v239
    v_fma_f32 v249, v249, v250, v232
    v_add_f32 v249, v249, v233
    v_add_f32 v249, v249, v234
    v_add_f32 v249, v249, v235
    v_add_f32 v249, v249, v236
    v_add_f32 v249, v249, v237
    v_add_f32 v249, v249, v238
    v_add_f32 v249, v249, v239
    v_mul_f32 v176, v176, v250
    v_mul_f32 v177, v177, v250
    v_mul_f32 v178, v178, v250
    v_mul_f32 v179, v179, v250
    v_mul_f32 v180, v180, v250
    v_mul_f32 v181, v181, v250
    v_mul_f32 v182, v182, v250
    v_mul_f32 v183, v183, v250
    v_mul_f32 v184, v184, v250
    v_mul_f32 v185, v185, v250
    v_mul_f32 v186, v186, v250
    v_mul_f32 v187, v187, v250
    v_mul_f32 v188, v188, v250
    v_mul_f32 v189, v189, v250
    v_mul_f32 v190, v190, v250
    v_mul_f32 v191, v191, v250
    v_mul_f32 v192, v192, v250
    v_mul_f32 v193, v193, v250
    v_mul_f32 v194, v194, v250
    v_mul_f32 v195, v195, v250
    v_mul_f32 v196, v196, v250
    v_mul_f32 v197, v197, v250
    v_mul_f32 v198, v198, v250
    v_mul_f32 v199, v199, v250
    v_mul_f32 v200, v200, v250
    v_mul_f32 v201, v201, v250
    v_mul_f32 v202, v202, v250
    v_mul_f32 v203, v203, v250
    v_mul_f32 v204, v204, v250
    v_mul_f32 v205, v205, v250
    v_mul_f32 v206, v206, v250
    v_mul_f32 v207, v207, v250
    s_cmp_ge_u32 s29, 64
    s_cbranch_scc1 m0_w2z
    s_cmp_ge_u32 s28, 64
    s_cbranch_scc1 m0_w2b
    s_waitcnt vmcnt(24)
    s_branch m0_w2c
m0_w2b:
    s_waitcnt vmcnt(16)
    s_branch m0_w2c
m0_w2z:
    s_waitcnt vmcnt(0)
m0_w2c:
    v_perm_b32 v144, v84, v80, s40
    v_perm_b32 v145, v92, v88, s40
    v_perm_b32 v146, v100, v96, s40
    v_perm_b32 v147, v108, v104, s40
    v_perm_b32 v148, v84, v80, s41
    v_perm_b32 v149, v92, v88, s41
    v_perm_b32 v150, v100, v96, s41
    v_perm_b32 v151, v108, v104, s41
    v_perm_b32 v152, v85, v81, s40
    v_perm_b32 v153, v93, v89, s40
    v_perm_b32 v154, v101, v97, s40
    v_perm_b32 v155, v109, v105, s40
    v_perm_b32 v156, v85, v81, s41
    v_perm_b32 v157, v93, v89, s41
    v_perm_b32 v158, v101, v97, s41
    v_perm_b32 v159, v109, v105, s41
    v_perm_b32 v160, v86, v82, s40
    v_perm_b32 v161, v94, v90, s40
    v_perm_b32 v162, v102, v98, s40
    v_perm_b32 v163, v110, v106, s40
    v_perm_b32 v164, v86, v82, s41
    v_perm_b32 v165, v94, v90, s41
    v_perm_b32 v166, v102, v98, s41
    v_perm_b32 v167, v110, v106, s41
    v_perm_b32 v168, v87, v83, s40
    v_perm_b32 v169, v95, v91, s40
    v_perm_b32 v170, v103, v99, s40
    v_perm_b32 v171, v111, v107, s40
    v_perm_b32 v172, v87, v83, s41
    v_perm_b32 v173, v95, v91, s41
    v_perm_b32 v174, v103, v99, s41
    v_perm_b32 v175, v111, v107, s41
    s_cmp_ge_u32 s28, 64
    s_cbranch_scc1 m0_nov
    s_mov_b32 s30, s28
    s_lshr_b32 s31, s30, 2
    s_add_u32 s31, s31, s30
    s_add_u32 s31, s31, s81
    s_and_b32 s31, s31, 3
    s_lshl_b32 s31, s31, 13
    s_lshl_b32 s30, s30, 15
    s_add_u32 s30, s30, s31
    s_add_u32 s30, s30, s17
    s_add_u32 s31, s30, 4096
    buffer_load_dwordx4 v[80:83], v6, s[24:27], s30 offen offset:0 nt
    buffer_load_dwordx4 v[84:87], v6, s[24:27], s30 offen offset:1024 nt
    buffer_load_dwordx4 v[88:91], v6, s[24:27], s30 offen offset:2048 nt
    buffer_load_dwordx4 v[92:95], v6, s[24:27], s30 offen offset:3072 nt
    buffer_load_dwordx4 v[96:99], v6, s[24:27], s31 offen offset:0 nt
    buffer_load_dwordx4 v[100:103], v6, s[24:27], s31 offen offset:1024 nt
    buffer_load_dwordx4 v[104:107], v6, s[24:27], s31 offen offset:2048 nt
    buffer_load_dwordx4 v[108:111], v6, s[24:27], s31 offen offset:3072 nt
m0_nov:
    s_nop 1
    v_mfma_f32_16x16x32_bf16 v[176:179], v[144:147], v[244:247], v[176:179]
    v_mfma_f32_16x16x32_bf16 v[180:183], v[148:151], v[244:247], v[180:183]
    v_mfma_f32_16x16x32_bf16 v[184:187], v[152:155], v[244:247], v[184:187]
    v_mfma_f32_16x16x32_bf16 v[188:191], v[156:159], v[244:247], v[188:191]
    v_mfma_f32_16x16x32_bf16 v[192:195], v[160:163], v[244:247], v[192:195]
    v_mfma_f32_16x16x32_bf16 v[196:199], v[164:167], v[244:247], v[196:199]
    v_mfma_f32_16x16x32_bf16 v[200:203], v[168:171], v[244:247], v[200:203]
    v_mfma_f32_16x16x32_bf16 v[204:207], v[172:175], v[244:247], v[204:207]
    s_nop 3
    s_cmp_ge_u32 s29, 64
    s_cbranch_scc1 m_done
    s_mov_b64 exec, 1
    ds_add_rtn_u32 v13, v15, v14
    s_mov_b64 exec, -1
    s_cmp_ge_u32 s28, 64
    s_cbranch_scc1 m1_w1b
    s_waitcnt vmcnt(24)
    s_branch m1_w1c
m1_w1b:
    s_waitcnt vmcnt(8)
m1_w1c:
    v_mfma_f32_16x16x32_bf16 v[224:227], v[48:51], v[208:211], 0
    v_mfma_f32_16x16x32_bf16 v[224:227], v[52:55], v[212:215], v[224:227]
    v_mfma_f32_16x16x32_bf16 v[224:227], v[56:59], v[216:219], v[224:227]
    v_mfma_f32_16x16x32_bf16 v[224:227], v[60:63], v[220:223], v[224:227]
    v_mfma_f32_16x16x32_bf16 v[228:231], v[64:67], v[208:211], 0
    v_mfma_f32_16x16x32_bf16 v[228:231], v[68:71], v[212:215], v[228:231]
    v_mfma_f32_16x16x32_bf16 v[228:231], v[72:75], v[216:219], v[228:231]
    v_mfma_f32_16x16x32_bf16 v[228:231], v[76:79], v[220:223], v[228:231]
    s_waitcnt lgkmcnt(0)
    v_readfirstlane_b32 s29, v13
    s_cmp_ge_u32 s29, 64
    s_cbranch_scc1 m1_nok
    s_mov_b32 s30, s29
    s_lshr_b32 s31, s30, 2
    s_add_u32 s31, s31, s30
    s_add_u32 s31, s31, s81
    s_and_b32 s31, s31, 3
    s_lshl_b32 s31, s31, 13
    s_lshl_b32 s30, s30, 15
    s_add_u32 s30, s30, s31
    s_add_u32 s30, s30, s17
    s_add_u32 s31, s30, 4096
    buffer_load_dwordx4 v[48:51], v5, s[20:23], s30 offen offset:0 nt
    buffer_load_dwordx4 v[52:55], v5, s[20:23], s30 offen offset:64 nt
    buffer_load_dwordx4 v[56:59], v5, s[20:23], s30 offen offset:128 nt
    buffer_load_dwordx4 v[60:63], v5, s[20:23], s30 offen offset:192 nt
    buffer_load_dwordx4 v[64:67], v5, s[20:23], s31 offen offset:0 nt
    buffer_load_dwordx4 v[68:71], v5, s[20:23], s31 offen offset:64 nt
    buffer_load_dwordx4 v[72:75], v5, s[20:23], s31 offen offset:128 nt
    buffer_load_dwordx4 v[76:79], v5, s[20:23], s31 offen offset:192 nt
m1_nok:
    s_nop 7
    v_cvt_pk_bf16_f32 v240, v224, v225
    v_cvt_pk_bf16_f32 v241, v226, v227
    v_cvt_pk_bf16_f32 v242, v228, v229
    v_cvt_pk_bf16_f32 v243, v230, v231
    v_lshlrev_b32 v232, 16, v240
    v_and_b32 v233, 0xffff0000, v240
    v_lshlrev_b32 v234, 16, v241
    v_and_b32 v235, 0xffff0000, v241
    v_lshlrev_b32 v236, 16, v242
    v_and_b32 v237, 0xffff0000, v242
    v_lshlrev_b32 v238, 16, v243
    v_and_b32 v239, 0xffff0000, v243
    v_mul_f32 v232, s43, v232
    v_mul_f32 v233, s43, v233
    v_mul_f32 v234, s43, v234
    v_mul_f32 v235, s43, v235
    v_mul_f32 v236, s43, v236
    v_mul_f32 v237, s43, v237
    v_mul_f32 v238, s43, v238
    v_mul_f32 v239, s43, v239
    v_cvt_pk_bf16_f32 v240, v232, v233
    v_cvt_pk_bf16_f32 v241, v234, v235
    v_cvt_pk_bf16_f32 v242, v236, v237
    v_cvt_pk_bf16_f32 v243, v238, v239
    v_lshlrev_b32 v232, 16, v240
    v_and_b32 v233, 0xffff0000, v240
    v_lshlrev_b32 v234, 16, v241
    v_and_b32 v235, 0xffff0000, v241
    v_lshlrev_b32 v236, 16, v242
    v_and_b32 v237, 0xffff0000, v242
    v_lshlrev_b32 v238, 16, v243
    v_and_b32 v239, 0xffff0000, v243
    v_max3_f32 v250, v232, v233, v234
    v_max3_f32 v250, v250, v235, v236
    v_max3_f32 v250, v250, v237, v238
    v_max_f32 v250, v250, v239
    v_mov_b32 v252, v250
    v_mov_b32 v253, v250
    s_nop 1
    v_permlane16_swap_b32 v252, v253
    s_nop 0
    v_max_f32 v250, v252, v253
    v_mov_b32 v252, v250
    v_mov_b32 v253, v250
    s_nop 1
    v_permlane32_swap_b32 v252, v253
    s_nop 0
    v_max_f32 v250, v252, v253
    v_max_f32 v252, v248, v250
    v_sub_f32 v253, v248, v252
    v_mul_f32 v253, s42, v253
    v_exp_f32 v250, v253
    v_mov_b32 v248, v252
    v_mul_f32 v251, s42, v248
    v_fma_f32 v232, v232, s42, -v251
    v_fma_f32 v233, v233, s42, -v251
    v_fma_f32 v234, v234, s42, -v251
    v_fma_f32 v235, v235, s42, -v251
    v_fma_f32 v236, v236, s42, -v251
    v_fma_f32 v237, v237, s42, -v251
    v_fma_f32 v238, v238, s42, -v251
    v_fma_f32 v239, v239, s42, -v251
    v_exp_f32 v232, v232
    v_exp_f32 v233, v233
    v_exp_f32 v234, v234
    v_exp_f32 v235, v235
    v_exp_f32 v236, v236
    v_exp_f32 v237, v237
    v_exp_f32 v238, v238
    v_exp_f32 v239, v239
    s_nop 0
    v_cvt_pk_bf16_f32 v244, v232, v233
    v_cvt_pk_bf16_f32 v245, v234, v235
    v_cvt_pk_bf16_f32 v246, v236, v237
    v_cvt_pk_bf16_f32 v247, v238, v239
    v_fma_f32 v249, v249, v250, v232
    v_add_f32 v249, v249, v233
    v_add_f32 v249, v249, v234
    v_add_f32 v249, v249, v235
    v_add_f32 v249, v249, v236
    v_add_f32 v249, v249, v237
    v_add_f32 v249, v249, v238
    v_add_f32 v249, v249, v239
    v_mul_f32 v176, v176, v250
    v_mul_f32 v177, v177, v250
    v_mul_f32 v178, v178, v250
    v_mul_f32 v179, v179, v250
    v_mul_f32 v180, v180, v250
    v_mul_f32 v181, v181, v250
    v_mul_f32 v182, v182, v250
    v_mul_f32 v183, v183, v250
    v_mul_f32 v184, v184, v250
    v_mul_f32 v185, v185, v250
    v_mul_f32 v186, v186, v250
    v_mul_f32 v187, v187, v250
    v_mul_f32 v188, v188, v250
    v_mul_f32 v189, v189, v250
    v_mul_f32 v190, v190, v250
    v_mul_f32 v191, v191, v250
    v_mul_f32 v192, v192, v250
    v_mul_f32 v193, v193, v250
    v_mul_f32 v194, v194, v250
    v_mul_f32 v195, v195, v250
    v_mul_f32 v196, v196, v250
    v_mul_f32 v197, v197, v250
    v_mul_f32 v198, v198, v250
    v_mul_f32 v199, v199, v250
    v_mul_f32 v200, v200, v250
    v_mul_f32 v201, v201, v250
    v_mul_f32 v202, v202, v250
    v_mul_f32 v203, v203, v250
    v_mul_f32 v204, v204, v250
    v_mul_f32 v205, v205, v250
    v_mul_f32 v206, v206, v250
    v_mul_f32 v207, v207, v250
    s_cmp_ge_u32 s28, 64
    s_cbranch_scc1 m1_w2z
    s_cmp_ge_u32 s29, 64
    s_cbranch_scc1 m1_w2b
    s_waitcnt vmcnt(24)
    s_branch m1_w2c
m1_w2b:
    s_waitcnt vmcnt(16)
    s_branch m1_w2c
m1_w2z:
    s_waitcnt vmcnt(0)
m1_w2c:
    v_perm_b32 v144, v116, v112, s40
    v_perm_b32 v145, v124, v120, s40
    v_perm_b32 v146, v132, v128, s40
    v_perm_b32 v147, v140, v136, s40
    v_perm_b32 v148, v116, v112, s41
    v_perm_b32 v149, v124, v120, s41
    v_perm_b32 v150, v132, v128, s41
    v_perm_b32 v151, v140, v136, s41
    v_perm_b32 v152, v117, v113, s40
    v_perm_b32 v153, v125, v121, s40
    v_perm_b32 v154, v133, v129, s40
    v_perm_b32 v155, v141, v137, s40
    v_perm_b32 v156, v117, v113, s41
    v_perm_b32 v157, v125, v121, s41
    v_perm_b32 v158, v133, v129, s41
    v_perm_b32 v159, v141, v137, s41
    v_perm_b32 v160, v118, v114, s40
    v_perm_b32 v161, v126, v122, s40
    v_perm_b32 v162, v134, v130, s40
    v_perm_b32 v163, v142, v138, s40
    v_perm_b32 v164, v118, v114, s41
    v_perm_b32 v165, v126, v122, s41
    v_perm_b32 v166, v134, v130, s41
    v_perm_b32 v167, v142, v138, s41
    v_perm_b32 v168, v119, v115, s40
    v_perm_b32 v169, v127, v123, s40
    v_perm_b32 v170, v135, v131, s40
    v_perm_b32 v171, v143, v139, s40
    v_perm_b32 v172, v119, v115, s41
    v_perm_b32 v173, v127, v123, s41
    v_perm_b32 v174, v135, v131, s41
    v_perm_b32 v175, v143, v139, s41
    s_cmp_ge_u32 s29, 64
    s_cbranch_scc1 m1_nov
    s_mov_b32 s30, s29
    s_lshr_b32 s31, s30, 2
    s_add_u32 s31, s31, s30
    s_add_u32 s31, s31, s81
    s_and_b32 s31, s31, 3
    s_lshl_b32 s31, s31, 13
    s_lshl_b32 s30, s30, 15
    s_add_u32 s30, s30, s31
    s_add_u32 s30, s30, s17
    s_add_u32 s31, s30, 4096
    buffer_load_dwordx4 v[112:115], v6, s[24:27], s30 offen offset:0 nt
    buffer_load_dwordx4 v[116:119], v6, s[24:27], s30 offen offset:1024 nt
    buffer_load_dwordx4 v[120:123], v6, s[24:27], s30 offen offset:2048 nt
    buffer_load_dwordx4 v[124:127], v6, s[24:27], s30 offen offset:3072 nt
    buffer_load_dwordx4 v[128:131], v6, s[24:27], s31 offen offset:0 nt
    buffer_load_dwordx4 v[132:135], v6, s[24:27], s31 offen offset:1024 nt
    buffer_load_dwordx4 v[136:139], v6, s[24:27], s31 offen offset:2048 nt
    buffer_load_dwordx4 v[140:143], v6, s[24:27], s31 offen offset:3072 nt
m1_nov:
    s_nop 1
    v_mfma_f32_16x16x32_bf16 v[176:179], v[144:147], v[244:247], v[176:179]
    v_mfma_f32_16x16x32_bf16 v[180:183], v[148:151], v[244:247], v[180:183]
    v_mfma_f32_16x16x32_bf16 v[184:187], v[152:155], v[244:247], v[184:187]
    v_mfma_f32_16x16x32_bf16 v[188:191], v[156:159], v[244:247], v[188:191]
    v_mfma_f32_16x16x32_bf16 v[192:195], v[160:163], v[244:247], v[192:195]
    v_mfma_f32_16x16x32_bf16 v[196:199], v[164:167], v[244:247], v[196:199]
    v_mfma_f32_16x16x32_bf16 v[200:203], v[168:171], v[244:247], v[200:203]
    v_mfma_f32_16x16x32_bf16 v[204:207], v[172:175], v[244:247], v[204:207]
    s_nop 3
    s_branch m_loop
m_done:
    s_lshl_b32 s18, s84, 17
    s_lshl_b32 s36, s16, 15
    s_add_u32 s18, s18, s36
    s_lshl_b32 s36, s81, 8
    s_add_u32 s18, s18, s36
    s_cmp_lt_u32 s2, 184
    s_cselect_b32 s18, s18, 0x7f000000
    s_cmp_lt_u32 s16, 4
    s_cselect_b32 s18, s18, 0x7f000000
    s_add_u32 s19, s18, 4096
    v_lshlrev_b32 v7, 13, v3
    v_lshlrev_b32 v9, 4, v4
    v_add_u32 v7, v7, v9
    buffer_load_dwordx4 v[16:19], v7, s[72:75], s18 offen offset:0
    buffer_load_dwordx4 v[20:23], v7, s[72:75], s18 offen offset:1024
    buffer_load_dwordx4 v[24:27], v7, s[72:75], s18 offen offset:2048
    buffer_load_dwordx4 v[28:31], v7, s[72:75], s18 offen offset:3072
    buffer_load_dwordx4 v[32:35], v7, s[72:75], s19 offen offset:0
    buffer_load_dwordx4 v[36:39], v7, s[72:75], s19 offen offset:1024
    buffer_load_dwordx4 v[40:43], v7, s[72:75], s19 offen offset:2048
    buffer_load_dwordx4 v[44:47], v7, s[72:75], s19 offen offset:3072
    s_nop 9
    v_mov_b32 v252, v249
    v_mov_b32 v253, v249
    s_nop 1
    v_permlane16_swap_b32 v252, v253
    s_nop 0
    v_add_f32 v249, v252, v253
    v_mov_b32 v252, v249
    v_mov_b32 v253, v249
    s_nop 1
    v_permlane32_swap_b32 v252, v253
    s_nop 0
    v_add_f32 v249, v252, v253
    v_lshlrev_b32 v8, 2, v4
    v_add_u32 v8, v8, v3
    v_lshlrev_b32 v8, 4, v8
    s_lshl_b32 s36, s16, 11
    v_add_u32 v8, s36, v8
    v_lshlrev_b32 v9, 3, v4
    s_lshl_b32 s36, s16, 5
    v_add_u32 v9, s36, v9
    v_mov_b32 v252, v248
    v_mov_b32 v253, v249
    v_cmp_gt_u32 vcc, 4, v4
    s_and_saveexec_b64 s[38:39], vcc
    ds_write_b128 v8, v[176:179] offset:0
    ds_write_b128 v8, v[180:183] offset:256
    ds_write_b128 v8, v[184:187] offset:512
    ds_write_b128 v8, v[188:191] offset:768
    ds_write_b128 v8, v[192:195] offset:1024
    ds_write_b128 v8, v[196:199] offset:1280
    ds_write_b128 v8, v[200:203] offset:1536
    ds_write_b128 v8, v[204:207] offset:1792
    ds_write_b64 v9, v[252:253] offset:40960
    s_mov_b64 exec, s[38:39]
    s_waitcnt lgkmcnt(0)
    s_barrier
    s_cmp_ge_u32 s16, 4
    s_cbranch_scc1 t_merged
    s_lshl_b32 s36, s16, 3
    v_mov_b32 v11, s36
    ds_read_b64 v[80:81], v11 offset:40960
    ds_read_b64 v[82:83], v11 offset:40992
    ds_read_b64 v[84:85], v11 offset:41024
    ds_read_b64 v[86:87], v11 offset:41056
    ds_read_b64 v[88:89], v11 offset:41088
    ds_read_b64 v[90:91], v11 offset:41120
    ds_read_b64 v[92:93], v11 offset:41152
    ds_read_b64 v[94:95], v11 offset:41184
    v_lshrrev_b32 v12, 3, v2
    v_lshlrev_b32 v12, 8, v12
    v_and_b32 v13, 7, v2
    v_lshlrev_b32 v13, 3, v13
    v_add_u32 v12, v12, v13
    s_lshl_b32 s36, s16, 6
    v_add_u32 v12, s36, v12
    ds_read_b64 v[96:97], v12 offset:0
    ds_read_b64 v[98:99], v12 offset:2048
    ds_read_b64 v[100:101], v12 offset:4096
    ds_read_b64 v[102:103], v12 offset:6144
    ds_read_b64 v[104:105], v12 offset:8192
    ds_read_b64 v[106:107], v12 offset:10240
    ds_read_b64 v[108:109], v12 offset:12288
    ds_read_b64 v[110:111], v12 offset:14336
    s_waitcnt lgkmcnt(0)
    v_max3_f32 v112, v80, v82, v84
    v_max3_f32 v112, v112, v86, v88
    v_max3_f32 v112, v112, v90, v92
    v_max_f32 v112, v112, v94
    v_sub_f32 v120, v80, v112
    v_mul_f32 v120, s42, v120
    v_exp_f32 v120, v120
    s_nop 0
    v_mul_f32 v113, v120, v81
    v_mul_f32 v116, v120, v96
    v_mul_f32 v117, v120, v97
    v_sub_f32 v120, v82, v112
    v_mul_f32 v120, s42, v120
    v_exp_f32 v120, v120
    s_nop 0
    v_fmac_f32 v113, v120, v83
    v_fmac_f32 v116, v120, v98
    v_fmac_f32 v117, v120, v99
    v_sub_f32 v120, v84, v112
    v_mul_f32 v120, s42, v120
    v_exp_f32 v120, v120
    s_nop 0
    v_fmac_f32 v113, v120, v85
    v_fmac_f32 v116, v120, v100
    v_fmac_f32 v117, v120, v101
    v_sub_f32 v120, v86, v112
    v_mul_f32 v120, s42, v120
    v_exp_f32 v120, v120
    s_nop 0
    v_fmac_f32 v113, v120, v87
    v_fmac_f32 v116, v120, v102
    v_fmac_f32 v117, v120, v103
    v_sub_f32 v120, v88, v112
    v_mul_f32 v120, s42, v120
    v_exp_f32 v120, v120
    s_nop 0
    v_fmac_f32 v113, v120, v89
    v_fmac_f32 v116, v120, v104
    v_fmac_f32 v117, v120, v105
    v_sub_f32 v120, v90, v112
    v_mul_f32 v120, s42, v120
    v_exp_f32 v120, v120
    s_nop 0
    v_fmac_f32 v113, v120, v91
    v_fmac_f32 v116, v120, v106
    v_fmac_f32 v117, v120, v107
    v_sub_f32 v120, v92, v112
    v_mul_f32 v120, s42, v120
    v_exp_f32 v120, v120
    s_nop 0
    v_fmac_f32 v113, v120, v93
    v_fmac_f32 v116, v120, v108
    v_fmac_f32 v117, v120, v109
    v_sub_f32 v120, v94, v112
    v_mul_f32 v120, s42, v120
    v_exp_f32 v120, v120
    s_nop 0
    v_fmac_f32 v113, v120, v95
    v_fmac_f32 v116, v120, v110
    v_fmac_f32 v117, v120, v111
    v_mov_b32 v114, s86
    v_mov_b32 v115, s87
    v_mov_b32 v118, s86
    v_mov_b32 v119, s87
    s_and_b32 s36, s2, 0xfc
    s_add_u32 s36, s36, s16
    s_lshl_b32 s36, s36, 2
    s_add_u32 s36, s36, s81
    s_lshl_b32 s37, s36, 10
    s_add_u32 s37, s37, 2097152
    v_lshlrev_b32 v12, 4, v2
    buffer_store_dwordx4 v[116:119], v12, s[44:47], s37 offen sc1
    s_lshl_b32 s37, s36, 4
    s_add_u32 s37, s37, 3145728
    v_mov_b32 v12, 0
    s_mov_b64 exec, 1
    buffer_store_dwordx4 v[112:115], v12, s[44:47], s37 offen sc1
    s_mov_b64 exec, -1
t_merged:
    s_cmp_lt_u32 s2, 184
    s_cbranch_scc0 t_final
    s_cmp_lt_u32 s80, 32
    s_cbranch_scc0 t_ffn
    s_lshl_b32 s36, s16, 5
    s_add_u32 s36, s36, s80
    s_lshl_b32 s32, s36, 12
    s_add_u32 s32, s32, 2097152
    s_lshl_b32 s33, s36, 6
    s_add_u32 s33, s33, 3145728
    v_lshlrev_b32 v12, 4, v2
    v_mov_b32 v13, 0
t_poll1:
    buffer_load_dwordx4 v[112:115], v12, s[44:47], s32 offen offset:0 sc1
    buffer_load_dwordx4 v[116:119], v12, s[44:47], s32 offen offset:1024 sc1
    buffer_load_dwordx4 v[120:123], v12, s[44:47], s32 offen offset:2048 sc1
    buffer_load_dwordx4 v[124:127], v12, s[44:47], s32 offen offset:3072 sc1
    buffer_load_dwordx4 v[128:131], v13, s[44:47], s33 offen offset:0 sc1
    buffer_load_dwordx4 v[132:135], v13, s[44:47], s33 offen offset:16 sc1
    buffer_load_dwordx4 v[136:139], v13, s[44:47], s33 offen offset:32 sc1
    buffer_load_dwordx4 v[140:143], v13, s[44:47], s33 offen offset:48 sc1
    s_waitcnt vmcnt(0)
    v_xor_b32 v14, s86, v114
    v_xor_b32 v15, s87, v115
    v_or_b32 v14, v14, v15
    v_xor_b32 v15, s86, v118
    v_or_b32 v14, v14, v15
    v_xor_b32 v15, s87, v119
    v_or_b32 v14, v14, v15
    v_xor_b32 v15, s86, v122
    v_or_b32 v14, v14, v15
    v_xor_b32 v15, s87, v123
    v_or_b32 v14, v14, v15
    v_xor_b32 v15, s86, v126
    v_or_b32 v14, v14, v15
    v_xor_b32 v15, s87, v127
    v_or_b32 v14, v14, v15
    v_xor_b32 v15, s86, v130
    v_or_b32 v14, v14, v15
    v_xor_b32 v15, s87, v131
    v_or_b32 v14, v14, v15
    v_xor_b32 v15, s86, v134
    v_or_b32 v14, v14, v15
    v_xor_b32 v15, s87, v135
    v_or_b32 v14, v14, v15
    v_xor_b32 v15, s86, v138
    v_or_b32 v14, v14, v15
    v_xor_b32 v15, s87, v139
    v_or_b32 v14, v14, v15
    v_xor_b32 v15, s86, v142
    v_or_b32 v14, v14, v15
    v_xor_b32 v15, s87, v143
    v_or_b32 v14, v14, v15
    v_cmp_ne_u32 vcc, 0, v14
    s_nop 0
    s_cmp_eq_u64 vcc, 0
    s_cbranch_scc1 t_got1
    s_add_u32 s89, s89, 1
    s_cmp_gt_u32 s89, 0x1000000
    s_cbranch_scc1 t_got1
    s_sleep 1
    s_branch t_poll1
t_got1:
    v_max3_f32 v144, v128, v132, v136
    v_max_f32 v144, v144, v140
    v_sub_f32 v145, v128, v144
    v_mul_f32 v145, s42, v145
    v_exp_f32 v145, v145
    s_nop 0
    v_mul_f32 v146, v145, v129
    v_mul_f32 v147, v145, v112
    v_mul_f32 v148, v145, v113
    v_sub_f32 v145, v132, v144
    v_mul_f32 v145, s42, v145
    v_exp_f32 v145, v145
    s_nop 0
    v_fmac_f32 v146, v145, v133
    v_fmac_f32 v147, v145, v116
    v_fmac_f32 v148, v145, v117
    v_sub_f32 v145, v136, v144
    v_mul_f32 v145, s42, v145
    v_exp_f32 v145, v145
    s_nop 0
    v_fmac_f32 v146, v145, v137
    v_fmac_f32 v147, v145, v120
    v_fmac_f32 v148, v145, v121
    v_sub_f32 v145, v140, v144
    v_mul_f32 v145, s42, v145
    v_exp_f32 v145, v145
    s_nop 0
    v_fmac_f32 v146, v145, v141
    v_fmac_f32 v147, v145, v124
    v_fmac_f32 v148, v145, v125
    v_rcp_f32 v146, v146
    s_nop 0
    v_mul_f32 v147, v147, v146
    v_mul_f32 v148, v148, v146
    v_cvt_pk_bf16_f32 v149, v147, v148
    v_and_b32 v12, 7, v2
    v_lshlrev_b32 v12, 4, v12
    v_lshrrev_b32 v13, 3, v2
    v_add_u32 v12, v12, v13
    v_lshlrev_b32 v12, 1, v12
    s_lshl_b32 s36, s16, 8
    v_add_u32 v12, s36, v12
    ds_write_b16 v12, v149 offset:42240
    ds_write_b16_d16_hi v12, v149 offset:42256
    s_branch t_join
t_ffn:
    s_mul_i32 s36, s16, 3840
    s_lshl_b32 s37, s84, 6
    s_add_u32 s36, s36, s37
    s_add_u32 s36, s36, 2048
    v_add_u32 v12, s36, v2
    v_lshlrev_b32 v12, 4, v12
t_pollf:
    s_mov_b32 s36, 0
    buffer_load_dwordx4 v[112:115], v12, s[44:47], s36 offen sc1
    s_mov_b32 s36, 14336
    buffer_load_dwordx4 v[128:131], v12, s[44:47], s36 offen sc1
    s_mov_b32 s36, 491520
    buffer_load_dwordx4 v[116:119], v12, s[44:47], s36 offen sc1
    s_mov_b32 s36, 505856
    buffer_load_dwordx4 v[132:135], v12, s[44:47], s36 offen sc1
    s_mov_b32 s36, 983040
    buffer_load_dwordx4 v[120:123], v12, s[44:47], s36 offen sc1
    s_mov_b32 s36, 997376
    buffer_load_dwordx4 v[136:139], v12, s[44:47], s36 offen sc1
    s_mov_b32 s36, 1474560
    buffer_load_dwordx4 v[124:127], v12, s[44:47], s36 offen sc1
    s_mov_b32 s36, 1488896
    buffer_load_dwordx4 v[140:143], v12, s[44:47], s36 offen sc1
    s_waitcnt vmcnt(0)
    v_xor_b32 v14, s86, v114
    v_xor_b32 v15, s87, v115
    v_or_b32 v14, v14, v15
    v_xor_b32 v15, s86, v118
    v_or_b32 v14, v14, v15
    v_xor_b32 v15, s87, v119
    v_or_b32 v14, v14, v15
    v_xor_b32 v15, s86, v122
    v_or_b32 v14, v14, v15
    v_xor_b32 v15, s87, v123
    v_or_b32 v14, v14, v15
    v_xor_b32 v15, s86, v126
    v_or_b32 v14, v14, v15
    v_xor_b32 v15, s87, v127
    v_or_b32 v14, v14, v15
    v_xor_b32 v15, s86, v130
    v_or_b32 v14, v14, v15
    v_xor_b32 v15, s87, v131
    v_or_b32 v14, v14, v15
    v_xor_b32 v15, s86, v134
    v_or_b32 v14, v14, v15
    v_xor_b32 v15, s87, v135
    v_or_b32 v14, v14, v15
    v_xor_b32 v15, s86, v138
    v_or_b32 v14, v14, v15
    v_xor_b32 v15, s87, v139
    v_or_b32 v14, v14, v15
    v_xor_b32 v15, s86, v142
    v_or_b32 v14, v14, v15
    v_xor_b32 v15, s87, v143
    v_or_b32 v14, v14, v15
    v_cmp_ne_u32 vcc, 0, v14
    s_nop 0
    s_cmp_eq_u64 vcc, 0
    s_cbranch_scc1 t_gotf
    s_add_u32 s89, s89, 1
    s_cmp_gt_u32 s89, 0x1000000
    s_cbranch_scc1 t_gotf
    s_sleep 1
    s_branch t_pollf
t_gotf:
    v_add_f32 v112, v112, v116
    v_add_f32 v120, v120, v124
    v_add_f32 v112, v112, v120
    v_cvt_pk_bf16_f32 v112, v112, v112
    v_lshlrev_b32 v112, 16, v112
    v_add_f32 v113, v113, v117
    v_add_f32 v121, v121, v125
    v_add_f32 v113, v113, v121
    v_cvt_pk_bf16_f32 v113, v113, v113
    v_lshlrev_b32 v113, 16, v113
    v_add_f32 v128, v128, v132
    v_add_f32 v136, v136, v140
    v_add_f32 v128, v128, v136
    v_cvt_pk_bf16_f32 v128, v128, v128
    v_lshlrev_b32 v128, 16, v128
    v_add_f32 v129, v129, v133
    v_add_f32 v137, v137, v141
    v_add_f32 v129, v129, v137
    v_cvt_pk_bf16_f32 v129, v129, v129
    v_lshlrev_b32 v129, 16, v129
    v_max_f32 v112, 0, v112
    v_mul_f32 v112, v112, v128
    v_max_f32 v113, 0, v113
    v_mul_f32 v113, v113, v129
    v_cvt_pk_bf16_f32 v149, v112, v113
    v_lshlrev_b32 v12, 2, v0
    ds_write_b32 v12, v149 offset:42240
t_join:
    s_waitcnt lgkmcnt(0)
    s_barrier
    s_cmp_ge_u32 s16, 4
    s_cbranch_scc1 t_hi
    v_mov_b32 v112, 0
    v_mov_b32 v113, 0
    v_mov_b32 v114, 0
    v_mov_b32 v115, 0
    v_lshlrev_b32 v12, 8, v4
    v_lshlrev_b32 v13, 4, v3
    v_add_u32 v12, v12, v13
    s_lshl_b32 s36, s16, 6
    v_add_u32 v12, s36, v12
    v_cmp_gt_u32 vcc, 8, v4
    s_and_saveexec_b64 s[38:39], vcc
    ds_read_b128 v[112:115], v12 offset:42240
    s_mov_b64 exec, s[38:39]
    s_waitcnt vmcnt(0) lgkmcnt(0)
    v_perm_b32 v144, v20, v16, s40
    v_perm_b32 v145, v28, v24, s40
    v_perm_b32 v146, v36, v32, s40
    v_perm_b32 v147, v44, v40, s40
    v_perm_b32 v148, v20, v16, s41
    v_perm_b32 v149, v28, v24, s41
    v_perm_b32 v150, v36, v32, s41
    v_perm_b32 v151, v44, v40, s41
    v_perm_b32 v152, v21, v17, s40
    v_perm_b32 v153, v29, v25, s40
    v_perm_b32 v154, v37, v33, s40
    v_perm_b32 v155, v45, v41, s40
    v_perm_b32 v156, v21, v17, s41
    v_perm_b32 v157, v29, v25, s41
    v_perm_b32 v158, v37, v33, s41
    v_perm_b32 v159, v45, v41, s41
    v_perm_b32 v160, v22, v18, s40
    v_perm_b32 v161, v30, v26, s40
    v_perm_b32 v162, v38, v34, s40
    v_perm_b32 v163, v46, v42, s40
    v_perm_b32 v164, v22, v18, s41
    v_perm_b32 v165, v30, v26, s41
    v_perm_b32 v166, v38, v34, s41
    v_perm_b32 v167, v46, v42, s41
    v_perm_b32 v168, v23, v19, s40
    v_perm_b32 v169, v31, v27, s40
    v_perm_b32 v170, v39, v35, s40
    v_perm_b32 v171, v47, v43, s40
    v_perm_b32 v172, v23, v19, s41
    v_perm_b32 v173, v31, v27, s41
    v_perm_b32 v174, v39, v35, s41
    v_perm_b32 v175, v47, v43, s41
    s_nop 1
    v_mfma_f32_16x16x32_bf16 v[176:179], v[144:147], v[112:115], 0
    v_mfma_f32_16x16x32_bf16 v[180:183], v[148:151], v[112:115], 0
    v_mfma_f32_16x16x32_bf16 v[184:187], v[152:155], v[112:115], 0
    v_mfma_f32_16x16x32_bf16 v[188:191], v[156:159], v[112:115], 0
    v_mfma_f32_16x16x32_bf16 v[192:195], v[160:163], v[112:115], 0
    v_mfma_f32_16x16x32_bf16 v[196:199], v[164:167], v[112:115], 0
    v_mfma_f32_16x16x32_bf16 v[200:203], v[168:171], v[112:115], 0
    v_mfma_f32_16x16x32_bf16 v[204:207], v[172:175], v[112:115], 0
    s_nop 9
    s_lshl_b32 s36, s16, 13
    v_lshlrev_b32 v11, 4, v2
    v_add_u32 v11, s36, v11
    ds_write_b128 v11, v[176:179] offset:8192
    ds_write_b128 v11, v[180:183] offset:9216
    ds_write_b128 v11, v[184:187] offset:10240
    ds_write_b128 v11, v[188:191] offset:11264
    ds_write_b128 v11, v[192:195] offset:12288
    ds_write_b128 v11, v[196:199] offset:13312
    ds_write_b128 v11, v[200:203] offset:14336
    ds_write_b128 v11, v[204:207] offset:15360
    s_waitcnt lgkmcnt(0)
    s_barrier
    v_lshrrev_b32 v12, 5, v0
    v_and_b32 v13, 7, v0
    v_bfe_u32 v14, v0, 3, 2
    v_lshlrev_b32 v15, 10, v12
    v_lshlrev_b32 v11, 4, v13
    v_add_u32 v15, v15, v11
    v_lshlrev_b32 v11, 8, v14
    v_add_u32 v15, v15, v11
    ds_read_b128 v[80:83], v15 offset:8192
    ds_read_b128 v[84:87], v15 offset:16384
    ds_read_b128 v[88:91], v15 offset:24576
    ds_read_b128 v[92:95], v15 offset:32768
    s_waitcnt lgkmcnt(0)
    v_add_f32 v80, v80, v84
    v_add_f32 v88, v88, v92
    v_add_f32 v96, v80, v88
    v_add_f32 v81, v81, v85
    v_add_f32 v89, v89, v93
    v_add_f32 v97, v81, v89
    v_add_f32 v82, v82, v86
    v_add_f32 v90, v90, v94
    v_add_f32 v100, v82, v90
    v_add_f32 v83, v83, v87
    v_add_f32 v91, v91, v95
    v_add_f32 v101, v83, v91
    v_mov_b32 v98, s86
    v_mov_b32 v99, s87
    v_mov_b32 v102, s86
    v_mov_b32 v103, s87
    s_lshl_b32 s36, s80, 3
    v_add_u32 v11, s36, v13
    v_lshlrev_b32 v11, 8, v11
    s_lshl_b32 s36, s81, 6
    v_add_u32 v11, s36, v11
    v_lshlrev_b32 v10, 2, v12
    v_add_u32 v11, v11, v10
    v_add_u32 v11, v11, v14
    v_lshlrev_b32 v11, 4, v11
    s_mov_b32 s36, 4194304
    buffer_store_dwordx4 v[96:99], v11, s[44:47], s36 offen offset:0 sc1
    buffer_store_dwordx4 v[100:103], v11, s[44:47], s36 offen offset:512 sc1
    s_endpgm
t_hi:
    s_barrier
    s_endpgm
t_final:
    s_cmp_ge_u32 s2, 216
    s_cbranch_scc1 k_end2
    s_sub_u32 s36, s2, 184
    s_lshl_b32 s37, s36, 6
    v_add_u32 v10, s37, v2
    v_lshlrev_b32 v11, 4, v10
    v_and_b32 v12, 3, v2
    v_lshlrev_b32 v12, 5, v12
    v_lshrrev_b32 v13, 5, v2
    v_lshlrev_b32 v13, 4, v13
    v_add_u32 v12, v12, v13
    v_bfe_u32 v13, v2, 2, 3
    v_add_u32 v12, v12, v13
    s_lshl_b32 s37, s36, 7
    v_add_u32 v12, s37, v12
    v_lshlrev_b32 v12, 1, v12
    buffer_load_ushort v13, v12, s[64:67], 0 offen
    buffer_load_ushort v9, v12, s[64:67], 0 offen offset:16
    s_lshl_b32 s32, s16, 15
    s_add_u32 s32, s32, 4194304
    s_cmp_lt_u32 s16, 6
    s_cselect_b32 s33, 5, 4
    s_lshl_b32 s33, s33, 18
    s_add_u32 s33, s33, s32
t_poll2:
    s_add_u32 s36, s32, 0
    buffer_load_dwordx4 v[16:19], v11, s[44:47], s36 offen sc1
    s_add_u32 s36, s32, 262144
    buffer_load_dwordx4 v[20:23], v11, s[44:47], s36 offen sc1
    s_add_u32 s36, s32, 524288
    buffer_load_dwordx4 v[24:27], v11, s[44:47], s36 offen sc1
    s_add_u32 s36, s32, 786432
    buffer_load_dwordx4 v[28:31], v11, s[44:47], s36 offen sc1
    s_add_u32 s36, s32, 1048576
    buffer_load_dwordx4 v[32:35], v11, s[44:47], s36 offen sc1
    buffer_load_dwordx4 v[36:39], v11, s[44:47], s33 offen sc1
    s_waitcnt vmcnt(0)
    v_xor_b32 v14, s86, v18
    v_xor_b32 v15, s87, v19
    v_or_b32 v14, v14, v15
    v_xor_b32 v15, s86, v22
    v_or_b32 v14, v14, v15
    v_xor_b32 v15, s87, v23
    v_or_b32 v14, v14, v15
    v_xor_b32 v15, s86, v26
    v_or_b32 v14, v14, v15
    v_xor_b32 v15, s87, v27
    v_or_b32 v14, v14, v15
    v_xor_b32 v15, s86, v30
    v_or_b32 v14, v14, v15
    v_xor_b32 v15, s87, v31
    v_or_b32 v14, v14, v15
    v_xor_b32 v15, s86, v34
    v_or_b32 v14, v14, v15
    v_xor_b32 v15, s87, v35
    v_or_b32 v14, v14, v15
    v_xor_b32 v15, s86, v38
    v_or_b32 v14, v14, v15
    v_xor_b32 v15, s87, v39
    v_or_b32 v14, v14, v15
    v_cmp_ne_u32 vcc, 0, v14
    s_nop 0
    s_cmp_eq_u64 vcc, 0
    s_cbranch_scc1 t_got2
    s_add_u32 s89, s89, 1
    s_cmp_gt_u32 s89, 0x1000000
    s_cbranch_scc1 t_got2
    s_sleep 1
    s_branch t_poll2
t_got2:
    s_cmp_lt_u32 s16, 6
    s_cselect_b32 s36, 1.0, 0
    v_add_f32 v48, v16, v20
    v_add_f32 v52, v24, v28
    v_add_f32 v48, v48, v52
    v_fma_f32 v50, v36, s36, v32
    v_add_f32 v49, v17, v21
    v_add_f32 v52, v25, v29
    v_add_f32 v49, v49, v52
    v_fma_f32 v51, v37, s36, v33
    s_lshl_b32 s36, s16, 10
    v_lshlrev_b32 v14, 4, v2
    v_add_u32 v15, s36, v14
    ds_write_b128 v15, v[48:51] offset:8192
    s_waitcnt lgkmcnt(0)
    s_barrier
    s_cmp_lg_u32 s16, 0
    s_cbranch_scc1 k_end2
    ds_read_b128 v[16:19], v14 offset:8192
    ds_read_b128 v[20:23], v14 offset:9216
    ds_read_b128 v[24:27], v14 offset:10240
    ds_read_b128 v[28:31], v14 offset:11264
    ds_read_b128 v[32:35], v14 offset:12288
    ds_read_b128 v[36:39], v14 offset:13312
    ds_read_b128 v[40:43], v14 offset:14336
    ds_read_b128 v[44:47], v14 offset:15360
    s_waitcnt lgkmcnt(0)
    v_add_f32 v16, v16, v20
    v_add_f32 v16, v16, v24
    v_add_f32 v16, v16, v28
    v_add_f32 v16, v16, v32
    v_add_f32 v16, v16, v36
    v_add_f32 v16, v16, v40
    v_add_f32 v16, v16, v44
    v_add_f32 v17, v17, v21
    v_add_f32 v17, v17, v25
    v_add_f32 v17, v17, v29
    v_add_f32 v17, v17, v33
    v_add_f32 v17, v17, v37
    v_add_f32 v17, v17, v41
    v_add_f32 v17, v17, v45
    v_add_f32 v18, v18, v22
    v_add_f32 v18, v18, v26
    v_add_f32 v18, v18, v30
    v_add_f32 v18, v18, v34
    v_add_f32 v18, v18, v38
    v_add_f32 v18, v18, v42
    v_add_f32 v18, v18, v46
    v_add_f32 v19, v19, v23
    v_add_f32 v19, v19, v27
    v_add_f32 v19, v19, v31
    v_add_f32 v19, v19, v35
    v_add_f32 v19, v19, v39
    v_add_f32 v19, v19, v43
    v_add_f32 v19, v19, v47
    v_cvt_pk_bf16_f32 v16, v16, v16
    v_lshlrev_b32 v16, 16, v16
    v_cvt_pk_bf16_f32 v18, v18, v18
    v_lshlrev_b32 v18, 16, v18
    v_mul_f32 v5, s42, v18
    v_exp_f32 v5, -v5
    s_nop 0
    v_add_f32 v5, 1.0, v5
    v_rcp_f32 v6, v5
    s_nop 0
    v_mul_f32 v7, v18, v6
    v_fma_f32 v8, -v7, v5, v18
    v_fma_f32 v7, v8, v6, v7
    v_cvt_pk_bf16_f32 v7, v7, v7
    v_lshlrev_b32 v7, 16, v7
    v_mul_f32 v7, v16, v7
    v_cvt_pk_bf16_f32 v7, v7, v7
    v_lshlrev_b32 v7, 16, v7
    v_lshlrev_b32 v13, 16, v13
    v_add_f32 v7, v13, v7
    v_cvt_pk_bf16_f32 v210, v7, v7
    buffer_store_short v210, v12, s[76:79], 0 offen offset:0
    v_cvt_pk_bf16_f32 v17, v17, v17
    v_lshlrev_b32 v17, 16, v17
    v_cvt_pk_bf16_f32 v19, v19, v19
    v_lshlrev_b32 v19, 16, v19
    v_mul_f32 v5, s42, v19
    v_exp_f32 v5, -v5
    s_nop 0
    v_add_f32 v5, 1.0, v5
    v_rcp_f32 v6, v5
    s_nop 0
    v_mul_f32 v7, v19, v6
    v_fma_f32 v8, -v7, v5, v19
    v_fma_f32 v7, v8, v6, v7
    v_cvt_pk_bf16_f32 v7, v7, v7
    v_lshlrev_b32 v7, 16, v7
    v_mul_f32 v7, v17, v7
    v_cvt_pk_bf16_f32 v7, v7, v7
    v_lshlrev_b32 v7, 16, v7
    v_lshlrev_b32 v9, 16, v9
    v_add_f32 v7, v9, v7
    v_cvt_pk_bf16_f32 v211, v7, v7
    buffer_store_short v211, v12, s[76:79], 0 offen offset:16
k_end2:
k_end:
    s_endpgm
.section .rodata,"a"
.p2align 6
.amdhsa_kernel recurrent_scan__gqa_block_cached__glu_gated_reglu__decode_kernel
  .amdhsa_next_free_vgpr 256
  .amdhsa_next_free_sgpr 102
  .amdhsa_accum_offset 256
  .amdhsa_group_segment_fixed_size 0
  .amdhsa_float_denorm_mode_32 3
  .amdhsa_kernarg_size 96
  .amdhsa_user_sgpr_count 2
  .amdhsa_user_sgpr_kernarg_segment_ptr 1
  .amdhsa_system_sgpr_workgroup_id_x 1
.end_amdhsa_kernel
```
